```python
import torch

def _softmax(x, axis=-1):
    return torch.softmax(x, dim=axis)

def _gelu(x):
    return torch.nn.functional.gelu(x, approximate='tanh')

def _silu(x):
    return torch.nn.functional.silu(x)

def _sigmoid(x):
    return torch.sigmoid(x)

def _layernorm(x, axis=-1, eps=1e-05):
    m = x.mean(dim=axis, keepdim=True)
    v = x.var(dim=axis, keepdim=True, unbiased=False)
    return (x - m) / torch.sqrt(v + eps)

def _scatter_add(tgt, idx, src, axis=0):
    return tgt.clone().index_add_(axis, idx, src)

def _segment_sum(src, seg, n):
    out = torch.zeros((n,) + src.shape[1:], dtype=src.dtype)
    return out.index_add_(0, seg, src)

def _pad(x, pw):
    flat = tuple((v for pair in reversed(pw) for v in pair))
    return torch.nn.functional.pad(x, flat)
kernel_name = 'adaLN_cond__compressed_kv_cla__dense_activation_relu__decode'

def setup_inputs():

    _w = lambda a: (lambda t: t.to(torch.bfloat16) if t.is_floating_point() else t)(torch.as_tensor(a))

    def _A_setup():
        B, H, Sq, Sk, D, M = (1, 32, 1, 8192, 192, 640)
        Dc = 4 * D
        return {'x': _w((lambda *s: torch.randn(*s, dtype=torch.bfloat16) * 0.1)(B, Sq, M)), 'c_kv': _w((lambda *s: torch.randn(*s, dtype=torch.bfloat16) * 3.2)(B, Sk, Dc)), 'w_q': _w((lambda *s: torch.randn(*s, dtype=torch.bfloat16) * 1.6)(M, H, D) * M ** (-0.5)), 'w_uk': _w((lambda *s: torch.randn(*s, dtype=torch.bfloat16) * 1.6)(Dc, H, D) * Dc ** (-0.5)), 'w_uv': _w((lambda *s: torch.randn(*s, dtype=torch.bfloat16) * 3.2)(Dc, H, D) * Dc ** (-0.5)), 'w_o': _w((lambda *s: torch.randn(*s, dtype=torch.bfloat16) * 3.2)(H, D, M) * (H * D) ** (-0.5))}
    _A_in = _A_setup()

    def _B_setup():
        B, S, D, Dff = (1, 1, 640, 1536)
        return {'x': _w((lambda *s: torch.randn(*s, dtype=torch.bfloat16) * 0.1)(B, S, D)), 'w1': _w((lambda *s: torch.randn(*s, dtype=torch.bfloat16) * 0.1)(D, Dff)), 'w2': _w((lambda *s: torch.randn(*s, dtype=torch.bfloat16) * 0.1)(Dff, D))}
    _B_in = _B_setup()
    return {'A_x': _A_in['x'], 'A_c_kv': _A_in['c_kv'], 'A_w_q': _A_in['w_q'], 'A_w_uk': _A_in['w_uk'], 'A_w_uv': _A_in['w_uv'], 'A_w_o': _A_in['w_o'], 'B_x': _B_in['x'], 'B_w1': _B_in['w1'], 'B_w2': _B_in['w2'], 'c': _w((lambda *s: torch.randn(*s, dtype=torch.bfloat16) * 0.8)(1, 640) * 8.0), 'w_mod': _w((lambda *s: torch.randn(*s, dtype=torch.bfloat16) * 0.8)(640, 6 * 640) * 640 ** (-0.5) * 8.0)}

def reference(A_x, A_c_kv, A_w_q, A_w_uk, A_w_uv, A_w_o, B_x, B_w1, B_w2, c, w_mod):

    def _A_ref(x, c_kv, w_q, w_uk, w_uv, w_o):
        B, Sq, M = (x.shape[0], x.shape[1], x.shape[2])
        Sk = c_kv.shape[1]
        H, D = (w_q.shape[1], w_q.shape[2])
        q = torch.einsum('bqm,mhd->bhqd', x, w_q)
        k = torch.einsum('bkc,chd->bhkd', c_kv, w_uk)
        v = torch.einsum('bkc,chd->bhkd', c_kv, w_uv)
        scores = torch.einsum('bhqd,bhkd->bhqk', q, k) * D ** (-0.5)
        off = Sk - Sq
        qi = torch.arange(Sq)[:, None]
        kj = torch.arange(Sk)[None, :]
        cmask = kj <= qi + off
        scores = torch.where(cmask[None, None], scores, -1000000000.0)
        p = _softmax(scores, axis=-1)
        ctx = torch.einsum('bhqk,bhkd->bhqd', p, v)
        return torch.einsum('bhqd,hdm->bqm', ctx, w_o)

    def _B_ref(x, w1, w2):
        h = torch.einsum('bsd,df->bsf', x, w1)
        zero = torch.zeros_like(h)
        h = torch.maximum(h, zero)
        return torch.einsum('bsf,fd->bsd', h, w2)
    x = A_x
    mod = (_silu(c) @ w_mod).reshape(c.shape[0], 6, 1, -1)
    sa, ca, ga, sb, cb, gb = (mod[:, 0].clone(), mod[:, 1].clone(), mod[:, 2].clone(), mod[:, 3].clone(), mod[:, 4].clone(), mod[:, 5].clone())
    h = _layernorm(x, axis=-1) * (1 + ca) + sa
    x = x + ga * _A_ref(h, A_c_kv, A_w_q, A_w_uk, A_w_uv, A_w_o)
    h = _layernorm(x, axis=-1) * (1 + cb) + sb
    x = x + gb * _B_ref(h, B_w1, B_w2)
    return x
```

```asm
; @launch grid=(256,1,1) block=(512,1,1) lds=163840
.amdgcn_target "amdgcn-amd-amdhsa--gfx950"
.text
.globl adaLN_cond__compressed_kv_cla__dense_activation_relu__decode_kernel
.p2align 8
.type adaLN_cond__compressed_kv_cla__dense_activation_relu__decode_kernel,@function
adaLN_cond__compressed_kv_cla__dense_activation_relu__decode_kernel:
    v_lshrrev_b32 v6, 6, v0
    v_and_b32 v1, 63, v0
    s_cmp_ge_u32 s2, 256
    s_cbranch_scc1 L_exit
    v_readfirstlane_b32 s58, v6
    v_mov_b32 v62, 163776
    s_cmp_eq_u32 s58, 6
    s_cbranch_scc0 L_skip_1
    v_mov_b32 v10, 0
    v_and_b32 v9, 15, v0
    v_lshl_add_u32 v9, v9, 2, v62
    ds_write_b32 v9, v10
    s_waitcnt lgkmcnt(0)
L_skip_1:
    s_cmp_eq_u32 s58, 5
    s_cbranch_scc0 L_skip_2
    s_getpc_b64 s[70:71]
L_pf_anchor:
    s_sub_u32 s70, s70, L_pf_anchor-adaLN_cond__compressed_kv_cla__dense_activation_relu__decode_kernel
    s_subb_u32 s71, s71, 0
    s_bfe_u32 s62, s2, 0x20003
    s_mul_i32 s62, s62, 6144
    v_lshl_add_u32 v12, v1, 7, s62
    v_min_u32 v12, L_exit-adaLN_cond__compressed_kv_cla__dense_activation_relu__decode_kernel, v12
    s_mov_b32 exec_lo, -1
    s_mov_b32 exec_hi, 0xffff
    global_load_dword v255, v12, s[70:71]
    s_mov_b64 exec, -1
L_skip_2:
    s_load_dwordx2 s[44:45], s[0:1], 80
    s_load_dwordx2 s[16:17], s[0:1], 16
    s_load_dwordx2 s[4:5], s[0:1], 104
    s_load_dwordx2 s[40:41], s[0:1], 72
    s_load_dwordx2 s[8:9], s[0:1], 0
    s_load_dwordx2 s[20:21], s[0:1], 24
    s_load_dwordx2 s[12:13], s[0:1], 8
    s_load_dwordx2 s[90:91], s[0:1], 104
    s_load_dwordx2 s[24:25], s[0:1], 32
    s_load_dwordx2 s[28:29], s[0:1], 40
    s_load_dwordx2 s[32:33], s[0:1], 56
    s_load_dwordx2 s[36:37], s[0:1], 64
    s_load_dwordx2 s[48:49], s[0:1], 88
    s_barrier
    s_and_b32 s52, s2, 7
    s_bfe_u32 s54, s2, 0x10003
    s_lshr_b32 s53, s2, 4
    s_and_b32 s56, s53, 7
    s_lshl_b32 s55, s54, 4
    s_lshl_b32 s57, s52, 1
    s_add_u32 s55, s55, s57
    s_add_u32 s57, s57, s54
    s_lshr_b32 s62, s53, 3
    s_add_u32 s55, s55, s62
    s_cmp_lt_u32 s2, 240
    s_cselect_b32 s59, s2, -1
    s_and_b32 s86, s2, 3
    s_lshr_b32 s87, s2, 2
    s_mov_b32 s46, 4915200
    s_mov_b32 s47, 0x20000
    s_mov_b32 s18, 7864320
    s_mov_b32 s19, 0x20000
    s_mov_b32 s42, 1280
    s_mov_b32 s43, 0x20000
    s_mov_b32 s10, 1280
    s_mov_b32 s11, 0x20000
    s_mov_b32 s6, 9961472
    s_mov_b32 s7, 0x20000
    v_lshlrev_b32 v30, 4, v1
    v_add_u32 v26, 0, v1
    v_mul_u32_u24 v27, 2731, v26
    v_lshrrev_b32 v27, 16, v27
    v_mul_u32_u24 v28, 24, v27
    v_sub_u32 v26, v26, v28
    v_and_b32 v28, 6, v27
    v_xor_b32 v26, v26, v28
    v_mul_u32_u24 v27, 12288, v27
    v_lshl_add_u32 v35, v26, 4, v27
    v_add_u32 v26, 64, v1
    v_mul_u32_u24 v27, 2731, v26
    v_lshrrev_b32 v27, 16, v27
    v_mul_u32_u24 v28, 24, v27
    v_sub_u32 v26, v26, v28
    v_and_b32 v28, 6, v27
    v_xor_b32 v26, v26, v28
    v_mul_u32_u24 v27, 12288, v27
    v_lshl_add_u32 v36, v26, 4, v27
    v_add_u32 v26, 128, v1
    v_mul_u32_u24 v27, 2731, v26
    v_lshrrev_b32 v27, 16, v27
    v_mul_u32_u24 v28, 24, v27
    v_sub_u32 v26, v26, v28
    v_and_b32 v28, 6, v27
    v_xor_b32 v26, v26, v28
    v_mul_u32_u24 v27, 12288, v27
    v_lshl_add_u32 v37, v26, 4, v27
    s_cmp_lt_u32 s58, 5
    s_cbranch_scc1 L_lo_first
    s_cmp_eq_u32 s58, 5
    s_cbranch_scc1 L_5_first
    s_cmp_eq_u32 s58, 6
    s_cbranch_scc1 L_6_first
    s_mul_i32 s62, s56, 983040
    s_mul_i32 s67, s55, 384
    s_add_u32 s62, s62, s67
    s_mov_b32 m0, 98304
    s_waitcnt lgkmcnt(0)
    buffer_load_dwordx4 v35, s[16:19], s62 offen nt lds
    s_add_u32 m0, m0, 1024
    s_nop 0
    buffer_load_dwordx4 v36, s[16:19], s62 offen nt lds
    s_add_u32 m0, m0, 1024
    s_nop 0
    buffer_load_dwordx4 v37, s[16:19], s62 offen nt lds
    s_add_u32 m0, m0, 1024
    s_add_u32 s62, s62, 98304
    buffer_load_dwordx4 v35, s[16:19], s62 offen nt lds
    s_add_u32 m0, m0, 1024
    s_nop 0
    buffer_load_dwordx4 v36, s[16:19], s62 offen nt lds
    s_add_u32 m0, m0, 1024
    s_nop 0
    buffer_load_dwordx4 v37, s[16:19], s62 offen nt lds
    s_add_u32 m0, m0, 1024
    s_add_u32 s62, s62, 98304
    buffer_load_dwordx4 v35, s[16:19], s62 offen nt lds
    s_add_u32 m0, m0, 1024
    s_nop 0
    buffer_load_dwordx4 v36, s[16:19], s62 offen nt lds
    s_add_u32 m0, m0, 1024
    s_nop 0
    buffer_load_dwordx4 v37, s[16:19], s62 offen nt lds
    s_add_u32 m0, m0, 1024
    s_add_u32 s62, s62, 98304
    buffer_load_dwordx4 v35, s[16:19], s62 offen nt lds
    s_add_u32 m0, m0, 1024
    s_nop 0
    buffer_load_dwordx4 v36, s[16:19], s62 offen nt lds
    s_add_u32 m0, m0, 1024
    s_nop 0
    buffer_load_dwordx4 v37, s[16:19], s62 offen nt lds
    s_add_u32 m0, m0, 1024
    s_add_u32 s62, s62, 98304
    s_mov_b32 s65, s62
    s_branch L_common
L_5_first:
    v_lshlrev_b32 v9, 2, v1
    s_mul_i32 s64, s86, 320
    s_waitcnt lgkmcnt(0)
    buffer_load_dword v10, v9, s[40:43], s64 offen
    buffer_load_dword v11, v9, s[40:43], s64 offen offset:256
    s_branch L_common
L_6_first:
    s_waitcnt lgkmcnt(0)
    s_branch L_common
L_lo_first:
    v_lshrrev_b32 v6, 3, v1
    v_and_b32 v7, 3, v6
    v_lshlrev_b32 v7, 1, v7
    v_and_b32 v8, 7, v1
    v_xor_b32 v7, v7, v8
    v_mul_u32_u24 v6, 7680, v6
    v_lshl_add_u32 v6, v7, 4, v6
    s_mul_i32 s62, s86, 1228800
    s_lshl_b32 s67, s87, 7
    s_add_u32 s62, s62, s67
    s_mul_i32 s67, s58, 61440
    s_add_u32 s62, s62, s67
    s_lshl_b32 s63, s58, 10
    s_add_u32 s63, s63, 129024
    s_mov_b32 m0, s63
    v_lshlrev_b32 v8, 2, v1
    s_waitcnt lgkmcnt(0)
    s_cmp_lt_u32 s58, 4
    s_cbranch_scc0 L_skip_3
    s_cmp_ge_i32 s59, 0
    s_cbranch_scc0 L_skip_4
    buffer_load_dwordx4 v6, s[44:47], s62 offen nt lds
    s_add_u32 m0, m0, 4096
    s_add_u32 s62, s62, 245760
    buffer_load_dwordx4 v6, s[44:47], s62 offen nt lds
    s_add_u32 m0, m0, 4096
    s_add_u32 s62, s62, 245760
    buffer_load_dwordx4 v6, s[44:47], s62 offen nt lds
    s_add_u32 m0, m0, 4096
    s_add_u32 s62, s62, 245760
    buffer_load_dwordx4 v6, s[44:47], s62 offen nt lds
    s_add_u32 m0, m0, 4096
    s_add_u32 s62, s62, 245760
    buffer_load_dwordx4 v6, s[44:47], s62 offen nt lds
L_skip_4:
    buffer_load_dword v40, v8, s[8:11], 0 offen
    buffer_load_dword v41, v8, s[8:11], 0 offen offset:256
    buffer_load_dword v42, v8, s[8:11], 0 offen offset:512
    buffer_load_dword v43, v8, s[8:11], 0 offen offset:768
    buffer_load_dword v44, v8, s[8:11], 0 offen offset:1024
    s_mul_i32 s64, s56, 160
    buffer_load_dword v45, v8, s[8:11], s64 offen
L_skip_3:
L_common:
    s_load_dword s3, s[90:91], 0
    s_mov_b32 s22, 9437184
    s_mov_b32 s23, 0x20000
    s_mov_b32 s14, 12582912
    s_mov_b32 s15, 0x20000
    s_mov_b32 s26, 9437184
    s_mov_b32 s27, 0x20000
    s_mov_b32 s30, 7864320
    s_mov_b32 s31, 0x20000
    s_mov_b32 s34, 1966080
    s_mov_b32 s35, 0x20000
    s_mov_b32 s38, 1966080
    s_mov_b32 s39, 0x20000
    s_mov_b32 s50, 1280
    s_mov_b32 s51, 0x20000
    s_add_u32 s62, s55, 32
    s_cmp_eq_u32 s54, 0
    s_cselect_b32 s62, s62, -1
    s_cmp_eq_u32 s56, 6
    s_cselect_b32 s60, s62, -1
    s_cmp_eq_u32 s56, 5
    s_cselect_b32 s60, s55, s60
    s_mov_b32 s78, 0xffff0000
    s_lshl_b32 s66, s55, 3
    s_add_u32 s66, s66, s56
    s_mul_i32 s79, s56, 1179648
    s_mul_i32 s67, s55, 384
    s_add_u32 s79, s79, s67
    v_lshrrev_b32 v2, 4, v1
    v_and_b32 v3, 15, v1
    v_bfe_u32 v4, v1, 2, 2
    v_and_b32 v5, 3, v1
    v_mov_b32 v46, -1
    v_mov_b32 v47, -1
    v_mov_b32 v48, -1
    v_mov_b32 v49, -1
    s_cmp_eq_u32 s58, 6
    s_cbranch_scc1 L_wave6
L_common2:
    v_cmp_eq_u32 s[80:81], 1, v2
    v_cmp_le_u32 s[82:83], 2, v2
    v_and_b32 v26, 1, v2
    v_cmp_eq_u32 s[84:85], 1, v26
    v_and_b32 v26, 1, v3
    v_cmp_eq_u32 s[72:73], 1, v26
    v_mov_b32 v52, 0x7fff0000
    v_mov_b32 v53, 0x7fff0000
    v_lshl_add_u32 v50, v2, 3, v4
    s_mov_b32 s75, 0x3dd53b95
    v_add_u32 v26, 0, v1
    v_mul_u32_u24 v27, 5462, v26
    v_lshrrev_b32 v27, 16, v27
    v_mul_u32_u24 v28, 12, v27
    v_sub_u32 v26, v26, v28
    v_mul_u32_u24 v27, 24576, v27
    v_lshl_add_u32 v32, v26, 4, v27
    v_add_u32 v26, 64, v1
    v_mul_u32_u24 v27, 5462, v26
    v_lshrrev_b32 v27, 16, v27
    v_mul_u32_u24 v28, 12, v27
    v_sub_u32 v26, v26, v28
    v_mul_u32_u24 v27, 24576, v27
    v_lshl_add_u32 v33, v26, 4, v27
    v_add_u32 v26, 128, v1
    v_mul_u32_u24 v27, 5462, v26
    v_lshrrev_b32 v27, 16, v27
    v_mul_u32_u24 v28, 12, v27
    v_sub_u32 v26, v26, v28
    v_mul_u32_u24 v27, 24576, v27
    v_lshl_add_u32 v34, v26, 4, v27
    s_mul_i32 s74, s57, 393216
    s_mul_i32 s67, s53, 1536
    s_add_u32 s74, s74, s67
    s_mul_i32 s67, s58, 192
    s_add_u32 s74, s74, s67
    s_add_u32 s74, s74, 2097152
    v_mul_u32_u24 v26, 400, v3
    v_lshl_add_u32 v26, v2, 4, v26
    v_add_u32 v51, 155648, v26
    v_lshlrev_b32 v236, 6, v3
    v_lshl_add_u32 v236, v2, 4, v236
    s_mul_i32 s70, s58, 12
    v_and_b32 v23, 7, v3
    v_lshlrev_b32 v23, 1, v23
    v_mul_u32_u24 v24, 1536, v3
    s_add_u32 s71, s70, 0
    v_add_u32 v25, s71, v2
    v_xor_b32 v25, v25, v23
    v_lshl_add_u32 v200, v25, 4, v24
    v_add_u32 v201, 49152, v200
    s_add_u32 s71, s70, 4
    v_add_u32 v25, s71, v2
    v_xor_b32 v25, v25, v23
    v_lshl_add_u32 v202, v25, 4, v24
    v_add_u32 v203, 49152, v202
    s_add_u32 s71, s70, 8
    v_add_u32 v25, s71, v2
    v_xor_b32 v25, v25, v23
    v_lshl_add_u32 v204, v25, 4, v24
    v_add_u32 v205, 49152, v204
    v_lshl_add_u32 v23, v2, 2, v4
    v_mul_u32_u24 v24, 1536, v23
    v_and_b32 v25, 1, v5
    v_lshl_add_u32 v24, v25, 3, v24
    v_and_b32 v23, 7, v23
    v_lshlrev_b32 v23, 1, v23
    v_lshrrev_b32 v25, 1, v5
    v_or_b32 v23, v23, v25
    s_add_u32 s71, s70, 0
    v_xor_b32 v25, s71, v23
    v_lshl_add_u32 v206, v25, 4, v24
    v_add_u32 v207, 49152, v206
    s_add_u32 s71, s70, 2
    v_xor_b32 v25, s71, v23
    v_lshl_add_u32 v208, v25, 4, v24
    v_add_u32 v209, 49152, v208
    s_add_u32 s71, s70, 4
    v_xor_b32 v25, s71, v23
    v_lshl_add_u32 v210, v25, 4, v24
    v_add_u32 v211, 49152, v210
    s_add_u32 s71, s70, 6
    v_xor_b32 v25, s71, v23
    v_lshl_add_u32 v212, v25, 4, v24
    v_add_u32 v213, 49152, v212
    s_add_u32 s71, s70, 8
    v_xor_b32 v25, s71, v23
    v_lshl_add_u32 v214, v25, 4, v24
    v_add_u32 v215, 49152, v214
    s_add_u32 s71, s70, 10
    v_xor_b32 v25, s71, v23
    v_lshl_add_u32 v216, v25, 4, v24
    v_add_u32 v217, 49152, v216
    s_lshl_b32 s70, s58, 12
    s_add_u32 s70, s70, 122880
    v_add_u32 v237, s70, v30
    s_lshr_b32 s70, s58, 1
    s_and_b32 s71, s58, 1
    s_lshl_b32 s70, s70, 10
    s_lshl_b32 s67, s71, 3
    s_add_u32 s70, s70, s67
    s_add_u32 s70, s70, 122880
    v_add_u32 v238, s70, v30
    s_lshl_b32 s70, s58, 2
    s_add_u32 s70, s70, 162048
    v_lshl_add_u32 v239, v3, 5, s70
    v_lshlrev_b32 v240, 5, v3
    v_add_u32 v240, 162048, v240
    s_lshr_b32 s70, s58, 2
    s_and_b32 s71, s58, 3
    s_lshl_b32 s70, s70, 10
    s_lshl_b32 s67, s71, 2
    s_add_u32 s70, s70, s67
    s_add_u32 s70, s70, 122880
    v_add_u32 v241, s70, v30
    v_add_u32 v242, 122880, v30
    s_mul_i32 s70, s58, 3328
    s_add_u32 s70, s70, 124928
    v_mul_u32_u24 v26, 208, v3
    v_lshl_add_u32 v26, v2, 3, v26
    v_add_u32 v243, s70, v26
    v_add_u32 v27, s70, v30
    v_add_u32 v23, 0, v1
    v_mul_u32_u24 v23, 5462, v23
    v_lshrrev_b32 v23, 16, v23
    v_lshl_add_u32 v244, v23, 4, v27
    v_add_u32 v23, 64, v1
    v_mul_u32_u24 v23, 5462, v23
    v_lshrrev_b32 v23, 16, v23
    v_lshl_add_u32 v245, v23, 4, v27
    v_add_u32 v23, 128, v1
    v_mul_u32_u24 v23, 5462, v23
    v_lshrrev_b32 v23, 16, v23
    v_lshl_add_u32 v246, v23, 4, v27
    s_cmp_eq_u32 s58, 7
    s_cbranch_scc1 L_streamer
    s_cmp_eq_u32 s58, 5
    s_cbranch_scc1 L_wave5
    s_cmp_eq_u32 s58, 6
    s_cbranch_scc1 L_wave6b
    s_waitcnt lgkmcnt(0)
    s_add_u32 s3, s3, 1
    s_cmp_lt_u32 s58, 4
    s_cbranch_scc0 L_skip_5
    s_cmp_ge_i32 s59, 0
    s_cbranch_scc0 L_skip_6
    v_and_b32 v14, 1, v3
    v_mul_u32_u24 v14, 320, v14
    v_lshl_add_u32 v14, v2, 4, v14
    v_add_u32 v14, 154624, v14
    v_lshrrev_b32 v15, 1, v5
    v_lshl_or_b32 v15, v4, 1, v15
    s_lshl_b32 s62, s58, 1
    v_xor_b32 v15, s62, v15
    v_lshlrev_b32 v15, 4, v15
    v_lshl_add_u32 v15, v50, 7, v15
    v_and_b32 v16, 1, v5
    v_lshl_add_u32 v15, v16, 3, v15
    v_add_u32 v15, 129024, v15
    v_lshlrev_b32 v17, 2, v3
    v_lshlrev_b32 v16, 3, v3
    v_mov_b32 v19, s3
    s_mul_i32 s62, s86, 10240
    s_lshl_b32 s67, s87, 9
    s_add_u32 s62, s62, s67
    s_lshl_b32 s67, s58, 7
    s_add_u32 s62, s62, s67
    s_add_u32 s62, s62, 8192
    s_mul_i32 s63, s86, 10240
    s_lshl_b32 s67, s87, 8
    s_add_u32 s63, s63, s67
    s_lshl_b32 s67, s58, 6
    s_add_u32 s63, s63, s67
    s_add_u32 s63, s63, 60416
    s_waitcnt vmcnt(0)
    v_mov_b32 v31, 1
    s_mov_b64 exec, 1
    ds_add_u32 v62, v31 offset:0
    s_mov_b64 exec, -1
    s_mov_b32 s68, 0x800000
L_fw_7:
    ds_read_b32 v31, v62 offset:0
    s_waitcnt lgkmcnt(0)
    v_cmp_gt_u32 vcc, 5, v31
    s_cbranch_vccz L_fd_8
    s_sub_u32 s68, s68, 1
    s_cbranch_scc0 L_fw_7
L_fd_8:
    ds_read_b128 v[64:67], v14 offset:0
    ds_read_b64_tr_b16 v[84:85], v15 offset:0
    ds_read_b64_tr_b16 v[86:87], v15 offset:512
    ds_read_b128 v[68:71], v14 offset:64
    ds_read_b64_tr_b16 v[88:89], v15 offset:4096
    ds_read_b64_tr_b16 v[90:91], v15 offset:4608
    ds_read_b128 v[72:75], v14 offset:128
    ds_read_b64_tr_b16 v[92:93], v15 offset:8192
    ds_read_b64_tr_b16 v[94:95], v15 offset:8704
    ds_read_b128 v[76:79], v14 offset:192
    ds_read_b64_tr_b16 v[96:97], v15 offset:12288
    ds_read_b64_tr_b16 v[98:99], v15 offset:12800
    ds_read_b128 v[80:83], v14 offset:256
    ds_read_b64_tr_b16 v[100:101], v15 offset:16384
    ds_read_b64_tr_b16 v[102:103], v15 offset:16896
    s_waitcnt lgkmcnt(12)
    v_mfma_f32_16x16x32_bf16 v[104:107], v[64:67], v[84:87], 0
    s_waitcnt lgkmcnt(9)
    v_mfma_f32_16x16x32_bf16 v[104:107], v[68:71], v[88:91], v[104:107]
    s_waitcnt lgkmcnt(6)
    v_mfma_f32_16x16x32_bf16 v[104:107], v[72:75], v[92:95], v[104:107]
    s_waitcnt lgkmcnt(3)
    v_mfma_f32_16x16x32_bf16 v[104:107], v[76:79], v[96:99], v[104:107]
    s_waitcnt lgkmcnt(0)
    v_mfma_f32_16x16x32_bf16 v[104:107], v[80:83], v[100:103], v[104:107]
    s_cmp_lt_u32 s59, 80
    s_cbranch_scc0 L_skip_9
    s_mov_b32 exec_lo, 0xffff
    s_mov_b32 exec_hi, 0
    s_nop 3
    v_add_f32 v18, v104, v105
    buffer_store_dwordx2 v[18:19], v16, s[4:7], s62 offen sc1
    s_branch L_end_10
L_skip_9:
    s_mov_b32 s68, 0x800000
L_fw_11:
    ds_read_b32 v31, v62 offset:4
    s_waitcnt lgkmcnt(0)
    v_cmp_gt_u32 vcc, 1, v31
    s_cbranch_vccz L_fd_12
    s_sub_u32 s68, s68, 1
    s_cbranch_scc0 L_fw_11
L_fd_12:
    s_mov_b32 exec_lo, 0xffff
    s_mov_b32 exec_hi, 0
    v_add_f32 v18, v104, v105
    buffer_store_dword v18, v17, s[4:7], s63 offen sc1
L_end_10:
    s_mov_b64 exec, -1
L_skip_6:
L_skip_5:
    s_cmp_lt_u32 s58, 4
    s_cbranch_scc0 L_skip_13
    s_waitcnt vmcnt(0)
    v_lshlrev_b32 v64, 16, v40
    v_and_b32 v65, s78, v40
    v_lshlrev_b32 v66, 16, v41
    v_and_b32 v67, s78, v41
    v_lshlrev_b32 v68, 16, v42
    v_and_b32 v69, s78, v42
    v_lshlrev_b32 v70, 16, v43
    v_and_b32 v71, s78, v43
    v_lshlrev_b32 v72, 16, v44
    v_and_b32 v73, s78, v44
    v_add_f32 v7, v64, v65
    v_add_f32 v7, v7, v66
    v_add_f32 v7, v7, v67
    v_add_f32 v7, v7, v68
    v_add_f32 v7, v7, v69
    v_add_f32 v7, v7, v70
    v_add_f32 v7, v7, v71
    v_add_f32 v7, v7, v72
    v_add_f32 v7, v7, v73
    s_nop 1
    v_add_f32_dpp v7, v7, v7 quad_perm:[1,0,3,2] row_mask:0xf bank_mask:0xf
    s_nop 1
    v_add_f32_dpp v7, v7, v7 quad_perm:[2,3,0,1] row_mask:0xf bank_mask:0xf
    s_nop 1
    v_add_f32_dpp v7, v7, v7 row_half_mirror row_mask:0xf bank_mask:0xf
    s_nop 1
    v_add_f32_dpp v7, v7, v7 row_mirror row_mask:0xf bank_mask:0xf
    v_mov_b32 v8, v7
    s_nop 1
    v_permlane16_swap_b32 v7, v8
    v_add_f32 v7, v7, v8
    v_mov_b32 v8, v7
    s_nop 1
    v_permlane32_swap_b32 v7, v8
    v_add_f32 v7, v7, v8
    v_mul_f32 v7, 0x3acccccd, v7
    v_sub_f32 v64, v64, v7
    v_sub_f32 v65, v65, v7
    v_sub_f32 v66, v66, v7
    v_sub_f32 v67, v67, v7
    v_sub_f32 v68, v68, v7
    v_sub_f32 v69, v69, v7
    v_sub_f32 v70, v70, v7
    v_sub_f32 v71, v71, v7
    v_sub_f32 v72, v72, v7
    v_sub_f32 v73, v73, v7
    v_mul_f32 v9, v64, v64
    v_fmac_f32 v9, v65, v65
    v_fmac_f32 v9, v66, v66
    v_fmac_f32 v9, v67, v67
    v_fmac_f32 v9, v68, v68
    v_fmac_f32 v9, v69, v69
    v_fmac_f32 v9, v70, v70
    v_fmac_f32 v9, v71, v71
    v_fmac_f32 v9, v72, v72
    v_fmac_f32 v9, v73, v73
    s_nop 1
    v_add_f32_dpp v9, v9, v9 quad_perm:[1,0,3,2] row_mask:0xf bank_mask:0xf
    s_nop 1
    v_add_f32_dpp v9, v9, v9 quad_perm:[2,3,0,1] row_mask:0xf bank_mask:0xf
    s_nop 1
    v_add_f32_dpp v9, v9, v9 row_half_mirror row_mask:0xf bank_mask:0xf
    s_nop 1
    v_add_f32_dpp v9, v9, v9 row_mirror row_mask:0xf bank_mask:0xf
    v_mov_b32 v8, v9
    s_nop 1
    v_permlane16_swap_b32 v9, v8
    v_add_f32 v9, v9, v8
    v_mov_b32 v8, v9
    s_nop 1
    v_permlane32_swap_b32 v9, v8
    v_add_f32 v9, v9, v8
    v_mov_b32 v10, 0x3727c5ac
    v_fmac_f32 v10, 0x3acccccd, v9
    v_rsq_f32 v10, v10
    v_lshlrev_b32 v38, 16, v45
    v_and_b32 v39, s78, v45
    v_sub_f32 v38, v38, v7
    v_sub_f32 v39, v39, v7
    v_mul_f32 v38, v38, v10
    v_mul_f32 v39, v39, v10
    v_lshlrev_b32 v52, 2, v3
    v_add_u32 v10, 128, v52
    v_cndmask_b32 v52, v52, v10, s[80:81]
    v_add_u32 v10, 64, v52
    v_cndmask_b32 v52, v52, v10, s[82:83]
    v_mov_b32 v10, 0x7fff0000
    v_cmp_eq_u32 vcc, 3, v2
    s_nop 1
    v_cndmask_b32 v52, v52, v10, vcc
    s_cmp_eq_u32 s58, 0
    s_cselect_b32 s88, 1.0, 0
    s_mul_i32 s64, s56, 640
    s_mul_i32 s67, s58, 10240
    s_add_u32 s64, s64, s67
    s_add_u32 s64, s64, 8192
    s_add_u32 s65, s64, 5120
    s_mul_i32 s62, s58, 352
    s_add_u32 s62, s62, 162048
    v_lshl_add_u32 v26, v1, 2, s62
    s_mov_b32 s68, 0x800000
L_fw_14:
    ds_read_b32 v31, v62 offset:36
    s_waitcnt lgkmcnt(0)
    v_cmp_gt_u32 vcc, 1, v31
    s_cbranch_vccz L_fd_15
    s_sub_u32 s68, s68, 1
    s_cbranch_scc0 L_fw_14
L_fd_15:
    s_mov_b32 exec_lo, -1
    s_mov_b32 exec_hi, 0xff
    buffer_load_dwordx4 v[14:17], v30, s[4:7], s64 offen sc1
    buffer_load_dwordx4 v[18:21], v30, s[4:7], s65 offen sc1
    s_mov_b64 exec, -1
    s_mov_b32 s68, 0x800000
L_fw_16:
    ds_read_b32 v31, v62 offset:24
    s_waitcnt lgkmcnt(0)
    v_cmp_gt_u32 vcc, 1, v31
    s_cbranch_vccz L_fd_17
    s_sub_u32 s68, s68, 1
    s_cbranch_scc0 L_fw_16
L_fd_17:
    v_mul_u32_u24 v7, 384, v50
    v_and_b32 v8, 1, v5
    v_lshl_add_u32 v7, v8, 3, v7
    v_add_u32 v7, 98304, v7
    v_lshrrev_b32 v8, 1, v5
    v_and_b32 v9, 2, v4
    v_or_b32 v8, v8, v9
    v_lshl_add_u32 v10, v2, 2, v4
    v_mul_u32_u24 v11, 384, v10
    v_and_b32 v12, 1, v5
    v_lshl_add_u32 v11, v12, 3, v11
    v_add_u32 v11, 122880, v11
    v_and_b32 v10, 6, v10
    v_lshrrev_b32 v12, 1, v5
    v_or_b32 v10, v10, v12
    s_mul_i32 s62, s58, 6
    s_add_u32 s63, s62, 0
    v_xor_b32 v13, s63, v8
    v_lshl_add_u32 v13, v13, 4, v7
    ds_read_b64_tr_b16 v[112:113], v13 offset:0
    ds_read_b64_tr_b16 v[116:117], v13 offset:12288
    s_add_u32 s63, s62, 0
    s_xor_b32 s63, s63, 4
    v_xor_b32 v13, s63, v8
    v_lshl_add_u32 v13, v13, 4, v7
    ds_read_b64_tr_b16 v[114:115], v13 offset:1536
    ds_read_b64_tr_b16 v[118:119], v13 offset:13824
    s_add_u32 s63, s62, 0
    v_xor_b32 v13, s63, v10
    v_lshl_add_u32 v13, v13, 4, v11
    ds_read_b64_tr_b16 v[120:121], v13
    s_add_u32 s63, s62, 2
    v_xor_b32 v13, s63, v8
    v_lshl_add_u32 v13, v13, 4, v7
    ds_read_b64_tr_b16 v[122:123], v13 offset:0
    ds_read_b64_tr_b16 v[126:127], v13 offset:12288
    s_add_u32 s63, s62, 2
    s_xor_b32 s63, s63, 4
    v_xor_b32 v13, s63, v8
    v_lshl_add_u32 v13, v13, 4, v7
    ds_read_b64_tr_b16 v[124:125], v13 offset:1536
    ds_read_b64_tr_b16 v[128:129], v13 offset:13824
    s_add_u32 s63, s62, 2
    v_xor_b32 v13, s63, v10
    v_lshl_add_u32 v13, v13, 4, v11
    ds_read_b64_tr_b16 v[130:131], v13
    s_add_u32 s63, s62, 4
    v_xor_b32 v13, s63, v8
    v_lshl_add_u32 v13, v13, 4, v7
    ds_read_b64_tr_b16 v[132:133], v13 offset:0
    ds_read_b64_tr_b16 v[136:137], v13 offset:12288
    s_add_u32 s63, s62, 4
    s_xor_b32 s63, s63, 4
    v_xor_b32 v13, s63, v8
    v_lshl_add_u32 v13, v13, 4, v7
    ds_read_b64_tr_b16 v[134:135], v13 offset:1536
    ds_read_b64_tr_b16 v[138:139], v13 offset:13824
    s_add_u32 s63, s62, 4
    v_xor_b32 v13, s63, v10
    v_lshl_add_u32 v13, v13, 4, v11
    ds_read_b64_tr_b16 v[140:141], v13
    s_mov_b32 exec_lo, -1
    s_mov_b32 exec_hi, 0xff
    s_mov_b32 s68, 400000
    s_waitcnt vmcnt(0)
    s_branch L_pchk_20
L_poll_18:
    buffer_load_dwordx4 v[14:17], v30, s[4:7], s64 offen sc1
    buffer_load_dwordx4 v[18:21], v30, s[4:7], s65 offen sc1
    s_waitcnt vmcnt(0)
L_pchk_20:
    v_xor_b32 v22, s3, v15
    v_xor_b32 v23, s3, v17
    v_xor_b32 v24, s3, v19
    v_xor_b32 v25, s3, v21
    v_or3_b32 v22, v22, v23, v24
    v_or_b32 v22, v22, v25
    v_cmp_ne_u32 vcc, 0, v22
    s_cbranch_vccz L_pdone_19
    s_sleep 1
    s_sub_u32 s68, s68, 1
    s_cbranch_scc0 L_poll_18
L_pdone_19:
    v_add_f32 v18, s88, v18
    v_add_f32 v20, s88, v20
    v_fmac_f32 v14, v38, v18
    v_fmac_f32 v16, v39, v20
    v_cvt_pk_bf16_f32 v22, v14, v16
    v_lshlrev_b32 v24, 16, v22
    v_and_b32 v25, s78, v22
    v_sub_f32 v24, v14, v24
    v_sub_f32 v25, v16, v25
    v_cvt_pk_bf16_f32 v23, v24, v25
    ds_write_b32 v26, v22
    ds_write_b32 v26, v23 offset:176
    v_mov_b32 v31, 1
    s_mov_b64 exec, 1
    ds_add_u32 v62, v31 offset:12
    s_mov_b64 exec, -1
    v_and_b32 v8, 7, v3
    v_mul_u32_u24 v8, 176, v8
    v_add_u32 v8, 162048, v8
    v_lshl_add_u32 v9, v2, 3, v8
    v_lshl_add_u32 v8, v2, 4, v8
    s_mul_i32 s62, s66, 1536
    s_mul_i32 s67, s58, 384
    s_add_u32 s62, s62, s67
    s_add_u32 s62, s62, 131072
    s_add_u32 s63, s62, 8388608
    v_lshlrev_b32 v27, 1, v52
    v_min_u32 v27, 0x7fff0000, v27
    s_mov_b32 s68, 0x800000
L_fw_21:
    ds_read_b32 v31, v62 offset:12
    s_waitcnt lgkmcnt(0)
    v_cmp_gt_u32 vcc, 4, v31
    s_cbranch_vccz L_fd_22
    s_sub_u32 s68, s68, 1
    s_cbranch_scc0 L_fw_21
L_fd_22:
    ds_read_b128 v[64:67], v8
    ds_read_b128 v[68:71], v8 offset:64
    ds_read_b64 v[72:73], v9 offset:128
    s_waitcnt lgkmcnt(2)
    v_mfma_f32_16x16x32_bf16 v[96:99], v[64:67], v[112:115], 0
    v_mfma_f32_16x16x32_bf16 v[100:103], v[64:67], v[122:125], 0
    v_mfma_f32_16x16x32_bf16 v[104:107], v[64:67], v[132:135], 0
    s_waitcnt lgkmcnt(1)
    v_mfma_f32_16x16x32_bf16 v[96:99], v[68:71], v[116:119], v[96:99]
    v_mfma_f32_16x16x32_bf16 v[100:103], v[68:71], v[126:129], v[100:103]
    v_mfma_f32_16x16x32_bf16 v[104:107], v[68:71], v[136:139], v[104:107]
    s_waitcnt lgkmcnt(0)
    v_mfma_f32_16x16x16_bf16 v[96:99], v[72:73], v[120:121], v[96:99]
    v_mfma_f32_16x16x16_bf16 v[100:103], v[72:73], v[130:131], v[100:103]
    v_mfma_f32_16x16x16_bf16 v[104:107], v[72:73], v[140:141], v[104:107]
    s_nop 5
    v_add_f32 v96, v96, v97
    v_add_f32 v98, v98, v99
    v_add_f32 v100, v100, v101
    v_add_f32 v102, v102, v103
    v_add_f32 v104, v104, v105
    v_add_f32 v106, v106, v107
    v_add_f32 v96, v96, v98
    v_add_f32 v100, v100, v102
    v_add_f32 v104, v104, v106
    v_cndmask_b32 v96, v96, v100, s[82:83]
    v_mov_b32 v97, s3
    s_nop 0
    v_permlane16_swap_b32 v96, v104
    v_add_f32 v96, v96, v104
    buffer_store_dwordx2 v[96:97], v27, s[4:7], s63 offen
    buffer_store_dwordx2 v[96:97], v27, s[4:7], s62 offen sc1
    v_mov_b32 v31, 1
    s_mov_b64 exec, 1
    ds_add_u32 v62, v31 offset:28
    s_mov_b64 exec, -1
L_skip_13:
    s_branch L_s3
L_wave5:
    s_cmp_ge_i32 s59, 0
    s_cbranch_scc0 L_skip_23
    s_waitcnt vmcnt(0)
    v_lshlrev_b32 v64, 16, v10
    v_and_b32 v65, s78, v10
    v_lshlrev_b32 v66, 16, v11
    v_and_b32 v67, s78, v11
    v_mul_f32 v68, 0xbfb8aa3b, v64
    v_mul_f32 v69, 0xbfb8aa3b, v65
    v_mul_f32 v70, 0xbfb8aa3b, v66
    v_mul_f32 v71, 0xbfb8aa3b, v67
    v_exp_f32 v68, v68
    v_exp_f32 v69, v69
    v_exp_f32 v70, v70
    v_exp_f32 v71, v71
    v_add_f32 v68, 1.0, v68
    v_add_f32 v69, 1.0, v69
    v_add_f32 v70, 1.0, v70
    v_add_f32 v71, 1.0, v71
    v_rcp_f32 v68, v68
    v_rcp_f32 v69, v69
    v_rcp_f32 v70, v70
    v_rcp_f32 v71, v71
    v_mul_f32 v64, v64, v68
    v_mul_f32 v65, v65, v69
    v_mul_f32 v66, v66, v70
    v_mul_f32 v67, v67, v71
    v_add_u32 v13, 154624, v9
    v_cvt_pk_bf16_f32 v14, v64, v65
    v_lshlrev_b32 v18, 16, v14
    v_and_b32 v19, s78, v14
    v_sub_f32 v18, v64, v18
    v_sub_f32 v19, v65, v19
    v_cvt_pk_bf16_f32 v15, v18, v19
    ds_write_b32 v13, v14
    ds_write_b32 v13, v15 offset:320
    v_cvt_pk_bf16_f32 v16, v66, v67
    v_lshlrev_b32 v18, 16, v16
    v_and_b32 v19, s78, v16
    v_sub_f32 v18, v66, v18
    v_sub_f32 v19, v67, v19
    v_cvt_pk_bf16_f32 v17, v18, v19
    s_mov_b32 exec_lo, 0xffff
    s_mov_b32 exec_hi, 0
    ds_write_b32 v13, v16 offset:256
    ds_write_b32 v13, v17 offset:576
    v_mov_b32 v31, 1
    s_mov_b64 exec, 1
    ds_add_u32 v62, v31 offset:0
    s_mov_b64 exec, -1
L_skip_23:
    s_waitcnt lgkmcnt(0)
    s_add_u32 s3, s3, 1
    s_waitcnt vmcnt(0)
    s_branch L_s3
L_wave6:
    s_getreg_b32 s69, hwreg(HW_REG_XCC_ID)
    s_and_b32 s69, s69, 15
    v_lshrrev_b32 v7, 2, v1
    v_lshlrev_b32 v7, 10, v7
    v_lshl_add_u32 v7, v5, 4, v7
    v_add_u32 v26, 0, v1
    v_mul_u32_u24 v27, 2731, v26
    v_lshrrev_b32 v27, 16, v27
    v_mul_u32_u24 v28, 24, v27
    v_sub_u32 v26, v26, v28
    v_mul_u32_u24 v27, 3072, v27
    v_lshl_add_u32 v9, v26, 4, v27
    v_add_u32 v26, 64, v1
    v_mul_u32_u24 v27, 2731, v26
    v_lshrrev_b32 v27, 16, v27
    v_mul_u32_u24 v28, 24, v27
    v_sub_u32 v26, v26, v28
    v_mul_u32_u24 v27, 3072, v27
    v_lshl_add_u32 v10, v26, 4, v27
    v_add_u32 v26, 128, v1
    v_mul_u32_u24 v27, 2731, v26
    v_lshrrev_b32 v27, 16, v27
    v_mul_u32_u24 v28, 24, v27
    v_sub_u32 v26, v26, v28
    v_mul_u32_u24 v27, 3072, v27
    v_lshl_add_u32 v11, v26, 4, v27
    s_mul_i32 s63, s66, 768
    s_add_u32 s63, s63, 655360
    s_and_b32 s64, s55, 15
    s_lshl_b32 s64, s64, 6
    s_mul_i32 s67, s54, 49152
    s_add_u32 s64, s64, s67
    s_mul_i32 s67, s56, 6144
    s_add_u32 s64, s64, s67
    s_add_u32 s64, s64, 524288
    s_mov_b32 exec_lo, 0xffffff
    s_mov_b32 exec_hi, 0
    buffer_store_dwordx4 v[46:49], v7, s[4:7], s64 offen sc1
    s_mov_b32 exec_lo, -1
    s_mov_b32 exec_hi, 0xffff
    buffer_store_dwordx4 v[46:49], v30, s[4:7], s63 offen sc1
    s_mov_b32 exec_lo, 0xffff
    s_mov_b32 exec_hi, 0
    s_mul_i32 s62, s55, 1280
    s_lshl_b32 s67, s56, 8
    s_add_u32 s62, s62, s67
    s_add_u32 s62, s62, 851968
    s_cmp_lt_u32 s56, 5
    s_cbranch_scc0 L_skip_24
    buffer_store_dwordx4 v[46:49], v30, s[4:7], s62 offen sc1
L_skip_24:
    s_mul_i32 s62, s86, 10240
    s_lshl_b32 s67, s87, 8
    s_add_u32 s62, s62, s67
    s_add_u32 s62, s62, 60416
    s_cmp_ge_i32 s59, 80
    s_cbranch_scc0 L_skip_25
    buffer_store_dwordx4 v[46:49], v30, s[4:7], s62 offen sc1
L_skip_25:
    s_cmp_lt_i32 s59, 0
    s_cbranch_scc0 L_skip_26
    s_mul_i32 s62, s2, 640
    s_add_u32 s62, s62, -38912
    s_mov_b32 exec_lo, -1
    s_mov_b32 exec_hi, 0xff
    buffer_store_dwordx4 v[46:49], v30, s[4:7], s62 offen sc1
L_skip_26:
    s_lshl_b32 s63, s54, 4
    s_add_u32 s63, s63, s53
    s_lshl_b32 s62, s63, 10
    s_lshl_b32 s67, s52, 7
    s_add_u32 s62, s62, s67
    s_add_u32 s62, s62, 1114112
    s_mov_b64 exec, 1
    buffer_store_dwordx2 v[46:47], v30, s[4:7], s62 offen sc1
    s_mov_b64 exec, -1
    s_mul_i32 s62, s63, 24576
    s_mul_i32 s67, s52, 384
    s_add_u32 s62, s62, s67
    s_add_u32 s62, s62, 1179648
    buffer_store_dwordx4 v[46:49], v9, s[4:7], s62 offen sc1
    buffer_store_dwordx4 v[46:49], v10, s[4:7], s62 offen sc1
    buffer_store_dwordx4 v[46:49], v11, s[4:7], s62 offen sc1
    s_cmp_ge_i32 s60, 0
    s_cbranch_scc0 L_skip_27
    v_lshrrev_b32 v12, 3, v1
    v_mul_u32_u24 v12, 6144, v12
    v_and_b32 v13, 7, v1
    v_lshl_add_u32 v12, v13, 4, v12
    s_lshl_b32 s62, s60, 7
    s_add_u32 s62, s62, 917504
    buffer_store_dwordx4 v[46:49], v12, s[4:7], s62 offen sc1
    s_add_u32 s62, s62, 49152
    buffer_store_dwordx4 v[46:49], v12, s[4:7], s62 offen sc1
    s_add_u32 s62, s62, 49152
    s_mov_b32 exec_lo, -1
    s_mov_b32 exec_hi, 0
    buffer_store_dwordx4 v[46:49], v12, s[4:7], s62 offen sc1
    s_mov_b64 exec, -1
L_skip_27:
    s_branch L_common2
L_wave6b:
    s_waitcnt lgkmcnt(0)
    s_add_u32 s3, s3, 1
    v_mov_b32 v14, s3
    v_mov_b32 v15, s69
    s_lshl_b32 s62, s66, 4
    s_add_u32 s62, s62, 4096
    s_waitcnt vmcnt(0)
    s_mov_b64 exec, 1
    buffer_store_dwordx2 v[14:15], v30, s[4:7], s62 offen sc1
    s_mov_b64 exec, -1
    v_mov_b32 v31, 1
    ds_write_b32 v62, v31 offset:4
    s_lshl_b32 s62, s57, 12
    s_lshl_b32 s67, s53, 8
    s_add_u32 s62, s62, s67
    s_add_u32 s62, s62, 1048576
    s_mul_i32 s63, s66, 768
    s_add_u32 s63, s63, 655360
    v_lshlrev_b32 v16, 7, v1
    s_mov_b32 exec_lo, 0x3
    s_mov_b32 exec_hi, 0
    buffer_load_dword v17, v16, s[4:7], s62 offen sc1
    s_mov_b32 exec_lo, 0x3f
    s_mov_b32 exec_hi, 0
    buffer_load_dword v17, v16, s[4:7], s63 offen sc1
    s_mov_b64 exec, -1
    s_lshl_b32 s63, s54, 11
    s_lshl_b32 s67, s52, 8
    s_add_u32 s63, s63, s67
    s_add_u32 s63, s63, 4096
    v_lshlrev_b32 v9, 4, v3
    s_mov_b32 s68, 0x800000
L_fw_28:
    ds_read_b32 v31, v62 offset:20
    s_waitcnt lgkmcnt(0)
    v_cmp_gt_u32 vcc, 6, v31
    s_cbranch_vccz L_fd_29
    s_sub_u32 s68, s68, 1
    s_cbranch_scc0 L_fw_28
L_fd_29:
    s_cmp_lt_i32 s59, 0
    s_cselect_b32 s62, 0, s60
    s_cmp_ge_i32 s62, 0
    s_cbranch_scc0 L_skip_30
    s_mov_b32 s62, 4096
    s_mov_b32 s68, 400000
L_poll_31:
    buffer_load_dwordx2 v[18:19], v9, s[4:7], s63 offen sc1
    buffer_load_dword v14, v30, s[4:7], s62 offen sc1
    buffer_load_dword v15, v30, s[4:7], s62 offen offset:1024 sc1
    buffer_load_dword v16, v30, s[4:7], s62 offen offset:2048 sc1
    buffer_load_dword v17, v30, s[4:7], s62 offen offset:3072 sc1
    s_waitcnt vmcnt(0)
    v_xor_b32 v18, s3, v18
    v_xor_b32 v14, s3, v14
    v_xor_b32 v15, s3, v15
    v_xor_b32 v16, s3, v16
    v_xor_b32 v17, s3, v17
    v_or3_b32 v20, v18, v14, v15
    v_or3_b32 v20, v20, v16, v17
    v_cmp_ne_u32 vcc, 0, v20
    s_cbranch_vccz L_pdone_32
    s_sleep 8
    s_sub_u32 s68, s68, 1
    s_cbranch_scc0 L_poll_31
L_pdone_32:
    s_branch L_end_34
L_skip_30:
    s_lshl_b32 s62, s54, 11
    s_add_u32 s62, s62, 4096
    s_mov_b32 s68, 400000
L_poll_35:
    buffer_load_dwordx2 v[18:19], v9, s[4:7], s63 offen sc1
    buffer_load_dword v14, v30, s[4:7], s62 offen sc1
    buffer_load_dword v15, v30, s[4:7], s62 offen offset:1024 sc1
    s_waitcnt vmcnt(0)
    v_xor_b32 v18, s3, v18
    v_xor_b32 v14, s3, v14
    v_xor_b32 v15, s3, v15
    v_or3_b32 v20, v18, v14, v15
    v_cmp_ne_u32 vcc, 0, v20
    s_cbranch_vccz L_pdone_36
    s_sleep 8
    s_sub_u32 s68, s68, 1
    s_cbranch_scc0 L_poll_35
L_pdone_36:
L_end_34:
    v_cmp_ne_u32 vcc, s69, v19
    s_cmp_eq_u64 vcc, 0
    s_cselect_b32 s61, 2, 1
    v_mov_b32 v31, s61
    ds_write_b32 v62, v31 offset:8
    s_branch L_s4go
L_streamer:
    s_mov_b32 s62, s65
    buffer_load_dwordx4 v35, s[16:19], s62 offen nt lds
    s_add_u32 m0, m0, 1024
    s_nop 0
    buffer_load_dwordx4 v36, s[16:19], s62 offen nt lds
    s_add_u32 m0, m0, 1024
    s_nop 0
    buffer_load_dwordx4 v37, s[16:19], s62 offen nt lds
    s_add_u32 m0, m0, 1024
    s_add_u32 s62, s62, 98304
    buffer_load_dwordx4 v35, s[16:19], s62 offen nt lds
    s_add_u32 m0, m0, 1024
    s_nop 0
    buffer_load_dwordx4 v36, s[16:19], s62 offen nt lds
    s_add_u32 m0, m0, 1024
    s_nop 0
    buffer_load_dwordx4 v37, s[16:19], s62 offen nt lds
    s_add_u32 m0, m0, 1024
    s_add_u32 s62, s62, 98304
    s_waitcnt vmcnt(17)
    buffer_load_dwordx4 v35, s[16:19], s62 offen nt lds
    s_add_u32 m0, m0, 1024
    s_waitcnt vmcnt(17)
    buffer_load_dwordx4 v36, s[16:19], s62 offen nt lds
    s_add_u32 m0, m0, 1024
    s_waitcnt vmcnt(17)
    buffer_load_dwordx4 v37, s[16:19], s62 offen nt lds
    s_add_u32 m0, m0, 1024
    s_add_u32 s62, s62, 98304
    s_waitcnt vmcnt(17)
    buffer_load_dwordx4 v35, s[16:19], s62 offen nt lds
    s_add_u32 m0, m0, 1024
    s_waitcnt vmcnt(17)
    buffer_load_dwordx4 v36, s[16:19], s62 offen nt lds
    s_add_u32 m0, m0, 1024
    s_waitcnt vmcnt(17)
    buffer_load_dwordx4 v37, s[16:19], s62 offen nt lds
    s_add_u32 m0, m0, 1024
    s_add_u32 s62, s62, 98304
    s_waitcnt vmcnt(17)
    buffer_load_dwordx4 v35, s[16:19], s62 offen nt lds
    s_add_u32 m0, m0, 1024
    s_waitcnt vmcnt(17)
    buffer_load_dwordx4 v36, s[16:19], s62 offen nt lds
    s_add_u32 m0, m0, 1024
    s_waitcnt vmcnt(17)
    buffer_load_dwordx4 v37, s[16:19], s62 offen nt lds
    s_add_u32 m0, m0, 1024
    s_add_u32 s62, s62, 98304
    v_add_u32 v26, 0, v1
    v_mul_u32_u24 v27, 683, v26
    v_lshrrev_b32 v27, 16, v27
    v_mul_u32_u24 v28, 96, v27
    v_sub_u32 v26, v26, v28
    v_lshlrev_b32 v28, 1, v27
    v_xor_b32 v26, v26, v28
    v_mul_u32_u24 v27, 1536, v27
    v_lshl_add_u32 v64, v26, 4, v27
    v_add_u32 v26, 64, v1
    v_mul_u32_u24 v27, 683, v26
    v_lshrrev_b32 v27, 16, v27
    v_mul_u32_u24 v28, 96, v27
    v_sub_u32 v26, v26, v28
    v_lshlrev_b32 v28, 1, v27
    v_xor_b32 v26, v26, v28
    v_mul_u32_u24 v27, 1536, v27
    v_lshl_add_u32 v65, v26, 4, v27
    v_add_u32 v26, 128, v1
    v_mul_u32_u24 v27, 683, v26
    v_lshrrev_b32 v27, 16, v27
    v_mul_u32_u24 v28, 96, v27
    v_sub_u32 v26, v26, v28
    v_lshlrev_b32 v28, 1, v27
    v_xor_b32 v26, v26, v28
    v_mul_u32_u24 v27, 1536, v27
    v_lshl_add_u32 v66, v26, 4, v27
    v_add_u32 v26, 192, v1
    v_mul_u32_u24 v27, 683, v26
    v_lshrrev_b32 v27, 16, v27
    v_mul_u32_u24 v28, 96, v27
    v_sub_u32 v26, v26, v28
    v_lshlrev_b32 v28, 1, v27
    v_xor_b32 v26, v26, v28
    v_mul_u32_u24 v27, 1536, v27
    v_lshl_add_u32 v67, v26, 4, v27
    v_add_u32 v26, 256, v1
    v_mul_u32_u24 v27, 683, v26
    v_lshrrev_b32 v27, 16, v27
    v_mul_u32_u24 v28, 96, v27
    v_sub_u32 v26, v26, v28
    v_lshlrev_b32 v28, 1, v27
    v_xor_b32 v26, v26, v28
    v_mul_u32_u24 v27, 1536, v27
    v_lshl_add_u32 v68, v26, 4, v27
    v_add_u32 v26, 320, v1
    v_mul_u32_u24 v27, 683, v26
    v_lshrrev_b32 v27, 16, v27
    v_mul_u32_u24 v28, 96, v27
    v_sub_u32 v26, v26, v28
    v_lshlrev_b32 v28, 1, v27
    v_xor_b32 v26, v26, v28
    v_mul_u32_u24 v27, 1536, v27
    v_lshl_add_u32 v69, v26, 4, v27
    v_add_u32 v26, 384, v1
    v_mul_u32_u24 v27, 683, v26
    v_lshrrev_b32 v27, 16, v27
    v_mul_u32_u24 v28, 96, v27
    v_sub_u32 v26, v26, v28
    v_lshlrev_b32 v28, 1, v27
    v_xor_b32 v26, v26, v28
    v_mul_u32_u24 v27, 1536, v27
    v_lshl_add_u32 v70, v26, 4, v27
    v_add_u32 v26, 448, v1
    v_mul_u32_u24 v27, 683, v26
    v_lshrrev_b32 v27, 16, v27
    v_mul_u32_u24 v28, 96, v27
    v_sub_u32 v26, v26, v28
    v_lshlrev_b32 v28, 1, v27
    v_xor_b32 v26, v26, v28
    v_mul_u32_u24 v27, 1536, v27
    v_lshl_add_u32 v71, v26, 4, v27
    v_add_u32 v26, 512, v1
    v_mul_u32_u24 v27, 683, v26
    v_lshrrev_b32 v27, 16, v27
    v_mul_u32_u24 v28, 96, v27
    v_sub_u32 v26, v26, v28
    v_lshlrev_b32 v28, 1, v27
    v_xor_b32 v26, v26, v28
    v_mul_u32_u24 v27, 1536, v27
    v_lshl_add_u32 v72, v26, 4, v27
    v_add_u32 v26, 576, v1
    v_mul_u32_u24 v27, 683, v26
    v_lshrrev_b32 v27, 16, v27
    v_mul_u32_u24 v28, 96, v27
    v_sub_u32 v26, v26, v28
    v_lshlrev_b32 v28, 1, v27
    v_xor_b32 v26, v26, v28
    v_mul_u32_u24 v27, 1536, v27
    v_lshl_add_u32 v73, v26, 4, v27
    v_add_u32 v26, 640, v1
    v_mul_u32_u24 v27, 683, v26
    v_lshrrev_b32 v27, 16, v27
    v_mul_u32_u24 v28, 96, v27
    v_sub_u32 v26, v26, v28
    v_lshlrev_b32 v28, 1, v27
    v_xor_b32 v26, v26, v28
    v_mul_u32_u24 v27, 1536, v27
    v_lshl_add_u32 v74, v26, 4, v27
    v_add_u32 v26, 704, v1
    v_mul_u32_u24 v27, 683, v26
    v_lshrrev_b32 v27, 16, v27
    v_mul_u32_u24 v28, 96, v27
    v_sub_u32 v26, v26, v28
    v_lshlrev_b32 v28, 1, v27
    v_xor_b32 v26, v26, v28
    v_mul_u32_u24 v27, 1536, v27
    v_lshl_add_u32 v75, v26, 4, v27
    s_waitcnt vmcnt(17)
    buffer_load_dwordx4 v35, s[16:19], s62 offen nt lds
    s_add_u32 m0, m0, 1024
    s_waitcnt vmcnt(17)
    buffer_load_dwordx4 v36, s[16:19], s62 offen nt lds
    s_add_u32 m0, m0, 1024
    s_waitcnt vmcnt(17)
    buffer_load_dwordx4 v37, s[16:19], s62 offen nt lds
    s_add_u32 m0, m0, 1024
    s_add_u32 s62, s62, 98304
    s_mov_b32 s62, s79
    s_mov_b32 m0, 61440
    s_waitcnt vmcnt(17)
    buffer_load_dwordx4 v35, s[20:23], s62 offen nt lds
    s_add_u32 m0, m0, 1024
    s_waitcnt vmcnt(17)
    buffer_load_dwordx4 v36, s[20:23], s62 offen nt lds
    s_add_u32 m0, m0, 1024
    s_waitcnt vmcnt(17)
    buffer_load_dwordx4 v37, s[20:23], s62 offen nt lds
    s_add_u32 m0, m0, 1024
    s_add_u32 s62, s62, 98304
    s_waitcnt vmcnt(17)
    buffer_load_dwordx4 v35, s[20:23], s62 offen nt lds
    s_add_u32 m0, m0, 1024
    s_waitcnt vmcnt(17)
    buffer_load_dwordx4 v36, s[20:23], s62 offen nt lds
    s_add_u32 m0, m0, 1024
    s_waitcnt vmcnt(17)
    buffer_load_dwordx4 v37, s[20:23], s62 offen nt lds
    s_add_u32 m0, m0, 1024
    s_add_u32 s62, s62, 98304
    s_waitcnt vmcnt(17)
    buffer_load_dwordx4 v35, s[20:23], s62 offen nt lds
    s_add_u32 m0, m0, 1024
    s_waitcnt vmcnt(17)
    buffer_load_dwordx4 v36, s[20:23], s62 offen nt lds
    s_add_u32 m0, m0, 1024
    s_waitcnt vmcnt(17)
    buffer_load_dwordx4 v37, s[20:23], s62 offen nt lds
    s_add_u32 m0, m0, 1024
    s_add_u32 s62, s62, 98304
    s_waitcnt vmcnt(17)
    buffer_load_dwordx4 v35, s[20:23], s62 offen nt lds
    s_add_u32 m0, m0, 1024
    s_waitcnt vmcnt(17)
    buffer_load_dwordx4 v36, s[20:23], s62 offen nt lds
    s_add_u32 m0, m0, 1024
    s_waitcnt vmcnt(17)
    buffer_load_dwordx4 v37, s[20:23], s62 offen nt lds
    s_add_u32 m0, m0, 1024
    s_add_u32 s62, s62, 98304
    s_waitcnt vmcnt(17)
    buffer_load_dwordx4 v35, s[20:23], s62 offen nt lds
    s_add_u32 m0, m0, 1024
    s_waitcnt vmcnt(17)
    buffer_load_dwordx4 v36, s[20:23], s62 offen nt lds
    s_add_u32 m0, m0, 1024
    s_waitcnt vmcnt(17)
    buffer_load_dwordx4 v37, s[20:23], s62 offen nt lds
    s_add_u32 m0, m0, 1024
    s_add_u32 s62, s62, 98304
    s_waitcnt vmcnt(17)
    buffer_load_dwordx4 v35, s[20:23], s62 offen nt lds
    s_add_u32 m0, m0, 1024
    s_waitcnt vmcnt(17)
    buffer_load_dwordx4 v36, s[20:23], s62 offen nt lds
    s_add_u32 m0, m0, 1024
    v_mov_b32 v31, 1
    ds_write_b32 v62, v31 offset:36
    s_waitcnt vmcnt(17)
    v_mov_b32 v31, 1
    ds_write_b32 v62, v31 offset:24
    buffer_load_dwordx4 v37, s[20:23], s62 offen nt lds
    s_add_u32 m0, m0, 1024
    s_add_u32 s62, s62, 98304
    s_waitcnt vmcnt(17)
    buffer_load_dwordx4 v35, s[20:23], s62 offen nt lds
    s_add_u32 m0, m0, 1024
    s_waitcnt vmcnt(17)
    buffer_load_dwordx4 v36, s[20:23], s62 offen nt lds
    s_add_u32 m0, m0, 1024
    s_waitcnt vmcnt(17)
    buffer_load_dwordx4 v37, s[20:23], s62 offen nt lds
    s_add_u32 m0, m0, 1024
    s_add_u32 s62, s62, 98304
    s_waitcnt vmcnt(17)
    buffer_load_dwordx4 v35, s[20:23], s62 offen nt lds
    s_add_u32 m0, m0, 1024
    s_waitcnt vmcnt(17)
    buffer_load_dwordx4 v36, s[20:23], s62 offen nt lds
    s_add_u32 m0, m0, 1024
    s_waitcnt vmcnt(17)
    buffer_load_dwordx4 v37, s[20:23], s62 offen nt lds
    s_add_u32 m0, m0, 1024
    s_add_u32 s62, s62, 98304
    s_waitcnt vmcnt(17)
    buffer_load_dwordx4 v35, s[20:23], s62 offen nt lds
    s_add_u32 m0, m0, 1024
    s_waitcnt vmcnt(17)
    buffer_load_dwordx4 v36, s[20:23], s62 offen nt lds
    s_add_u32 m0, m0, 1024
    s_waitcnt vmcnt(17)
    buffer_load_dwordx4 v37, s[20:23], s62 offen nt lds
    s_add_u32 m0, m0, 1024
    s_add_u32 s62, s62, 98304
    s_waitcnt vmcnt(17)
    buffer_load_dwordx4 v35, s[20:23], s62 offen nt lds
    s_add_u32 m0, m0, 1024
    s_waitcnt vmcnt(17)
    buffer_load_dwordx4 v36, s[20:23], s62 offen nt lds
    s_add_u32 m0, m0, 1024
    s_waitcnt vmcnt(17)
    buffer_load_dwordx4 v37, s[20:23], s62 offen nt lds
    s_add_u32 m0, m0, 1024
    s_add_u32 s62, s62, 98304
    s_waitcnt vmcnt(17)
    buffer_load_dwordx4 v35, s[20:23], s62 offen nt lds
    s_add_u32 m0, m0, 1024
    s_waitcnt vmcnt(17)
    buffer_load_dwordx4 v36, s[20:23], s62 offen nt lds
    s_add_u32 m0, m0, 1024
    s_waitcnt vmcnt(17)
    buffer_load_dwordx4 v37, s[20:23], s62 offen nt lds
    s_add_u32 m0, m0, 1024
    s_add_u32 s62, s62, 98304
    s_waitcnt vmcnt(17)
    buffer_load_dwordx4 v35, s[20:23], s62 offen nt lds
    s_add_u32 m0, m0, 1024
    s_waitcnt vmcnt(17)
    buffer_load_dwordx4 v36, s[20:23], s62 offen nt lds
    s_add_u32 m0, m0, 1024
    s_waitcnt vmcnt(17)
    buffer_load_dwordx4 v37, s[20:23], s62 offen nt lds
    s_add_u32 m0, m0, 1024
    s_add_u32 s62, s62, 98304
    s_mul_i32 s63, s52, 1572864
    s_mul_i32 s67, s53, 98304
    s_add_u32 s63, s63, s67
    s_mul_i32 s64, s54, 0
    s_mov_b32 m0, 0
    s_xor_b32 s62, s64, 0
    s_add_u32 s62, s62, s63
    s_waitcnt lgkmcnt(0)
    s_add_u32 s3, s3, 1
    v_mov_b32 v29, 0
    s_mul_i32 s65, s55, 245760
    buffer_load_dword v28, v29, s[24:27], s79 offen
    buffer_load_dword v28, v29, s[28:31], s65 offen
    buffer_load_dword v28, v29, s[32:35], 0 offen
    buffer_load_dword v28, v29, s[36:39], 0 offen
    s_waitcnt vmcnt(29)
    buffer_load_dwordx4 v64, s[12:15], s62 offen nt lds
    s_add_u32 m0, m0, 1024
    s_waitcnt vmcnt(29)
    buffer_load_dwordx4 v65, s[12:15], s62 offen nt lds
    s_add_u32 m0, m0, 1024
    s_waitcnt vmcnt(29)
    buffer_load_dwordx4 v66, s[12:15], s62 offen nt lds
    s_add_u32 m0, m0, 1024
    s_waitcnt vmcnt(29)
    buffer_load_dwordx4 v67, s[12:15], s62 offen nt lds
    s_add_u32 m0, m0, 1024
    s_waitcnt vmcnt(29)
    buffer_load_dwordx4 v68, s[12:15], s62 offen nt lds
    s_add_u32 m0, m0, 1024
    s_waitcnt vmcnt(29)
    buffer_load_dwordx4 v69, s[12:15], s62 offen nt lds
    s_add_u32 m0, m0, 1024
    s_waitcnt vmcnt(29)
    buffer_load_dwordx4 v70, s[12:15], s62 offen nt lds
    s_add_u32 m0, m0, 1024
    s_waitcnt vmcnt(29)
    buffer_load_dwordx4 v71, s[12:15], s62 offen nt lds
    s_add_u32 m0, m0, 1024
    s_waitcnt vmcnt(29)
    buffer_load_dwordx4 v72, s[12:15], s62 offen nt lds
    s_add_u32 m0, m0, 1024
    s_waitcnt vmcnt(29)
    buffer_load_dwordx4 v73, s[12:15], s62 offen nt lds
    s_add_u32 m0, m0, 1024
    s_waitcnt vmcnt(29)
    buffer_load_dwordx4 v74, s[12:15], s62 offen nt lds
    s_add_u32 m0, m0, 1024
    s_waitcnt vmcnt(29)
    buffer_load_dwordx4 v75, s[12:15], s62 offen nt lds
    s_add_u32 m0, m0, 1024
    s_waitcnt vmcnt(0)
    v_mov_b32 v31, 3
    ds_write_b32 v62, v31 offset:24
    s_mov_b32 s68, 0x800000
L_fw_38:
    ds_read_b32 v31, v62 offset:20
    s_waitcnt lgkmcnt(0)
    v_cmp_gt_u32 vcc, 6, v31
    s_cbranch_vccz L_fd_39
    s_sub_u32 s68, s68, 1
    s_cbranch_scc0 L_fw_38
L_fd_39:
    s_xor_b32 s62, s64, 0
    s_add_u32 s62, s62, s63
    s_add_u32 s62, s62, 12288
    s_waitcnt vmcnt(29)
    buffer_load_dwordx4 v64, s[12:15], s62 offen nt lds
    s_add_u32 m0, m0, 1024
    s_waitcnt vmcnt(29)
    buffer_load_dwordx4 v65, s[12:15], s62 offen nt lds
    s_add_u32 m0, m0, 1024
    s_waitcnt vmcnt(29)
    buffer_load_dwordx4 v66, s[12:15], s62 offen nt lds
    s_add_u32 m0, m0, 1024
    s_waitcnt vmcnt(29)
    buffer_load_dwordx4 v67, s[12:15], s62 offen nt lds
    s_add_u32 m0, m0, 1024
    s_waitcnt vmcnt(29)
    buffer_load_dwordx4 v68, s[12:15], s62 offen nt lds
    s_add_u32 m0, m0, 1024
    s_waitcnt vmcnt(29)
    buffer_load_dwordx4 v69, s[12:15], s62 offen nt lds
    s_add_u32 m0, m0, 1024
    s_waitcnt vmcnt(29)
    buffer_load_dwordx4 v70, s[12:15], s62 offen nt lds
    s_add_u32 m0, m0, 1024
    s_waitcnt vmcnt(29)
    buffer_load_dwordx4 v71, s[12:15], s62 offen nt lds
    s_add_u32 m0, m0, 1024
    s_waitcnt vmcnt(29)
    buffer_load_dwordx4 v72, s[12:15], s62 offen nt lds
    s_add_u32 m0, m0, 1024
    s_waitcnt vmcnt(29)
    buffer_load_dwordx4 v73, s[12:15], s62 offen nt lds
    s_add_u32 m0, m0, 1024
    s_waitcnt vmcnt(29)
    buffer_load_dwordx4 v74, s[12:15], s62 offen nt lds
    s_add_u32 m0, m0, 1024
    s_waitcnt vmcnt(29)
    buffer_load_dwordx4 v75, s[12:15], s62 offen nt lds
    s_add_u32 m0, m0, 1024
    s_xor_b32 s62, s64, 0
    s_add_u32 s62, s62, s63
    s_add_u32 s62, s62, 24576
    s_waitcnt vmcnt(29)
    buffer_load_dwordx4 v64, s[12:15], s62 offen nt lds
    s_add_u32 m0, m0, 1024
    s_waitcnt vmcnt(29)
    buffer_load_dwordx4 v65, s[12:15], s62 offen nt lds
    s_add_u32 m0, m0, 1024
    s_waitcnt vmcnt(29)
    buffer_load_dwordx4 v66, s[12:15], s62 offen nt lds
    s_add_u32 m0, m0, 1024
    s_waitcnt vmcnt(29)
    buffer_load_dwordx4 v67, s[12:15], s62 offen nt lds
    s_add_u32 m0, m0, 1024
    s_waitcnt vmcnt(29)
    buffer_load_dwordx4 v68, s[12:15], s62 offen nt lds
    s_add_u32 m0, m0, 1024
    s_waitcnt vmcnt(29)
    buffer_load_dwordx4 v69, s[12:15], s62 offen nt lds
    s_add_u32 m0, m0, 1024
    s_waitcnt vmcnt(29)
    buffer_load_dwordx4 v70, s[12:15], s62 offen nt lds
    s_add_u32 m0, m0, 1024
    s_waitcnt vmcnt(29)
    buffer_load_dwordx4 v71, s[12:15], s62 offen nt lds
    s_add_u32 m0, m0, 1024
    s_waitcnt vmcnt(29)
    buffer_load_dwordx4 v72, s[12:15], s62 offen nt lds
    s_add_u32 m0, m0, 1024
    s_waitcnt vmcnt(29)
    buffer_load_dwordx4 v73, s[12:15], s62 offen nt lds
    s_add_u32 m0, m0, 1024
    s_waitcnt vmcnt(29)
    buffer_load_dwordx4 v74, s[12:15], s62 offen nt lds
    s_add_u32 m0, m0, 1024
    s_waitcnt vmcnt(29)
    buffer_load_dwordx4 v75, s[12:15], s62 offen nt lds
    s_add_u32 m0, m0, 1024
    s_xor_b32 s62, s64, 0
    s_add_u32 s62, s62, s63
    s_add_u32 s62, s62, 36864
    s_waitcnt vmcnt(29)
    buffer_load_dwordx4 v64, s[12:15], s62 offen nt lds
    s_add_u32 m0, m0, 1024
    s_waitcnt vmcnt(29)
    buffer_load_dwordx4 v65, s[12:15], s62 offen nt lds
    s_add_u32 m0, m0, 1024
    s_waitcnt vmcnt(29)
    buffer_load_dwordx4 v66, s[12:15], s62 offen nt lds
    s_add_u32 m0, m0, 1024
    s_waitcnt vmcnt(29)
    buffer_load_dwordx4 v67, s[12:15], s62 offen nt lds
    s_add_u32 m0, m0, 1024
    s_waitcnt vmcnt(29)
    buffer_load_dwordx4 v68, s[12:15], s62 offen nt lds
    s_add_u32 m0, m0, 1024
    s_waitcnt vmcnt(29)
    buffer_load_dwordx4 v69, s[12:15], s62 offen nt lds
    s_add_u32 m0, m0, 1024
    s_waitcnt vmcnt(29)
    buffer_load_dwordx4 v70, s[12:15], s62 offen nt lds
    s_add_u32 m0, m0, 1024
    s_waitcnt vmcnt(29)
    buffer_load_dwordx4 v71, s[12:15], s62 offen nt lds
    s_add_u32 m0, m0, 1024
    s_waitcnt vmcnt(29)
    buffer_load_dwordx4 v72, s[12:15], s62 offen nt lds
    s_add_u32 m0, m0, 1024
    s_waitcnt vmcnt(29)
    buffer_load_dwordx4 v73, s[12:15], s62 offen nt lds
    s_add_u32 m0, m0, 1024
    s_waitcnt vmcnt(29)
    buffer_load_dwordx4 v74, s[12:15], s62 offen nt lds
    s_add_u32 m0, m0, 1024
    s_waitcnt vmcnt(29)
    buffer_load_dwordx4 v75, s[12:15], s62 offen nt lds
    s_add_u32 m0, m0, 1024
    s_xor_b32 s62, s64, 49152
    s_add_u32 s62, s62, s63
    s_waitcnt vmcnt(29)
    buffer_load_dwordx4 v64, s[12:15], s62 offen nt lds
    s_add_u32 m0, m0, 1024
    s_waitcnt vmcnt(29)
    buffer_load_dwordx4 v65, s[12:15], s62 offen nt lds
    s_add_u32 m0, m0, 1024
    s_waitcnt vmcnt(29)
    buffer_load_dwordx4 v66, s[12:15], s62 offen nt lds
    s_add_u32 m0, m0, 1024
    s_waitcnt vmcnt(29)
    buffer_load_dwordx4 v67, s[12:15], s62 offen nt lds
    s_add_u32 m0, m0, 1024
    s_waitcnt vmcnt(29)
    buffer_load_dwordx4 v68, s[12:15], s62 offen nt lds
    s_add_u32 m0, m0, 1024
    s_waitcnt vmcnt(29)
    buffer_load_dwordx4 v69, s[12:15], s62 offen nt lds
    s_add_u32 m0, m0, 1024
    s_waitcnt vmcnt(29)
    buffer_load_dwordx4 v70, s[12:15], s62 offen nt lds
    s_add_u32 m0, m0, 1024
    s_waitcnt vmcnt(29)
    buffer_load_dwordx4 v71, s[12:15], s62 offen nt lds
    s_add_u32 m0, m0, 1024
    s_waitcnt vmcnt(29)
    buffer_load_dwordx4 v72, s[12:15], s62 offen nt lds
    s_add_u32 m0, m0, 1024
    s_waitcnt vmcnt(29)
    buffer_load_dwordx4 v73, s[12:15], s62 offen nt lds
    s_add_u32 m0, m0, 1024
    s_waitcnt vmcnt(29)
    buffer_load_dwordx4 v74, s[12:15], s62 offen nt lds
    s_add_u32 m0, m0, 1024
    s_waitcnt vmcnt(29)
    buffer_load_dwordx4 v75, s[12:15], s62 offen nt lds
    s_add_u32 m0, m0, 1024
    s_xor_b32 s62, s64, 49152
    s_add_u32 s62, s62, s63
    s_add_u32 s62, s62, 12288
    s_mov_b32 s68, 0x800000
L_fw_40:
    ds_read_b32 v31, v62 offset:16
    s_waitcnt lgkmcnt(0)
    v_cmp_gt_u32 vcc, 3, v31
    s_cbranch_vccz L_fd_41
    s_sub_u32 s68, s68, 1
    s_cbranch_scc0 L_fw_40
L_fd_41:
    s_mov_b32 s68, 0x800000
L_fw_42:
    ds_read_b32 v31, v62 offset:28
    s_waitcnt lgkmcnt(0)
    v_cmp_gt_u32 vcc, 4, v31
    s_cbranch_vccz L_fd_43
    s_sub_u32 s68, s68, 1
    s_cbranch_scc0 L_fw_42
L_fd_43:
    s_waitcnt vmcnt(29)
    buffer_load_dwordx4 v64, s[12:15], s62 offen nt lds
    s_add_u32 m0, m0, 1024
    s_waitcnt vmcnt(29)
    buffer_load_dwordx4 v65, s[12:15], s62 offen nt lds
    s_add_u32 m0, m0, 1024
    s_waitcnt vmcnt(29)
    buffer_load_dwordx4 v66, s[12:15], s62 offen nt lds
    s_add_u32 m0, m0, 1024
    s_waitcnt vmcnt(29)
    buffer_load_dwordx4 v67, s[12:15], s62 offen nt lds
    s_add_u32 m0, m0, 1024
    s_waitcnt vmcnt(29)
    buffer_load_dwordx4 v68, s[12:15], s62 offen nt lds
    s_add_u32 m0, m0, 1024
    s_waitcnt vmcnt(29)
    buffer_load_dwordx4 v69, s[12:15], s62 offen nt lds
    s_add_u32 m0, m0, 1024
    s_waitcnt vmcnt(29)
    buffer_load_dwordx4 v70, s[12:15], s62 offen nt lds
    s_add_u32 m0, m0, 1024
    s_waitcnt vmcnt(29)
    buffer_load_dwordx4 v71, s[12:15], s62 offen nt lds
    s_add_u32 m0, m0, 1024
    s_waitcnt vmcnt(29)
    buffer_load_dwordx4 v72, s[12:15], s62 offen nt lds
    s_add_u32 m0, m0, 1024
    s_waitcnt vmcnt(29)
    buffer_load_dwordx4 v73, s[12:15], s62 offen nt lds
    s_add_u32 m0, m0, 1024
    s_waitcnt vmcnt(29)
    buffer_load_dwordx4 v74, s[12:15], s62 offen nt lds
    s_add_u32 m0, m0, 1024
    s_waitcnt vmcnt(29)
    buffer_load_dwordx4 v75, s[12:15], s62 offen nt lds
    s_add_u32 m0, m0, 1024
    s_xor_b32 s62, s64, 49152
    s_add_u32 s62, s62, s63
    s_add_u32 s62, s62, 24576
    s_waitcnt vmcnt(29)
    buffer_load_dwordx4 v64, s[12:15], s62 offen nt lds
    s_add_u32 m0, m0, 1024
    s_waitcnt vmcnt(29)
    buffer_load_dwordx4 v65, s[12:15], s62 offen nt lds
    s_add_u32 m0, m0, 1024
    s_waitcnt vmcnt(29)
    buffer_load_dwordx4 v66, s[12:15], s62 offen nt lds
    s_add_u32 m0, m0, 1024
    s_waitcnt vmcnt(29)
    buffer_load_dwordx4 v67, s[12:15], s62 offen nt lds
    s_add_u32 m0, m0, 1024
    s_waitcnt vmcnt(29)
    buffer_load_dwordx4 v68, s[12:15], s62 offen nt lds
    s_add_u32 m0, m0, 1024
    s_waitcnt vmcnt(29)
    buffer_load_dwordx4 v69, s[12:15], s62 offen nt lds
    s_add_u32 m0, m0, 1024
    s_waitcnt vmcnt(29)
    buffer_load_dwordx4 v70, s[12:15], s62 offen nt lds
    s_add_u32 m0, m0, 1024
    s_waitcnt vmcnt(29)
    buffer_load_dwordx4 v71, s[12:15], s62 offen nt lds
    s_add_u32 m0, m0, 1024
    s_waitcnt vmcnt(29)
    buffer_load_dwordx4 v72, s[12:15], s62 offen nt lds
    s_add_u32 m0, m0, 1024
    s_waitcnt vmcnt(29)
    buffer_load_dwordx4 v73, s[12:15], s62 offen nt lds
    s_add_u32 m0, m0, 1024
    s_waitcnt vmcnt(29)
    buffer_load_dwordx4 v74, s[12:15], s62 offen nt lds
    s_add_u32 m0, m0, 1024
    s_waitcnt vmcnt(29)
    buffer_load_dwordx4 v75, s[12:15], s62 offen nt lds
    s_add_u32 m0, m0, 1024
    s_xor_b32 s62, s64, 49152
    s_add_u32 s62, s62, s63
    s_add_u32 s62, s62, 36864
    s_waitcnt vmcnt(29)
    buffer_load_dwordx4 v64, s[12:15], s62 offen nt lds
    s_add_u32 m0, m0, 1024
    s_waitcnt vmcnt(29)
    buffer_load_dwordx4 v65, s[12:15], s62 offen nt lds
    s_add_u32 m0, m0, 1024
    s_waitcnt vmcnt(29)
    buffer_load_dwordx4 v66, s[12:15], s62 offen nt lds
    s_add_u32 m0, m0, 1024
    s_waitcnt vmcnt(29)
    buffer_load_dwordx4 v67, s[12:15], s62 offen nt lds
    s_add_u32 m0, m0, 1024
    s_waitcnt vmcnt(29)
    buffer_load_dwordx4 v68, s[12:15], s62 offen nt lds
    s_add_u32 m0, m0, 1024
    s_waitcnt vmcnt(29)
    buffer_load_dwordx4 v69, s[12:15], s62 offen nt lds
    s_add_u32 m0, m0, 1024
    s_waitcnt vmcnt(29)
    buffer_load_dwordx4 v70, s[12:15], s62 offen nt lds
    s_add_u32 m0, m0, 1024
    s_waitcnt vmcnt(29)
    buffer_load_dwordx4 v71, s[12:15], s62 offen nt lds
    s_add_u32 m0, m0, 1024
    s_waitcnt vmcnt(29)
    buffer_load_dwordx4 v72, s[12:15], s62 offen nt lds
    s_add_u32 m0, m0, 1024
    s_waitcnt vmcnt(29)
    buffer_load_dwordx4 v73, s[12:15], s62 offen nt lds
    s_add_u32 m0, m0, 1024
    s_waitcnt vmcnt(29)
    buffer_load_dwordx4 v74, s[12:15], s62 offen nt lds
    s_add_u32 m0, m0, 1024
    s_waitcnt vmcnt(29)
    buffer_load_dwordx4 v75, s[12:15], s62 offen nt lds
    s_add_u32 m0, m0, 1024
    s_mov_b32 s68, 0x800000
L_fw_44:
    ds_read_b32 v31, v62 offset:8
    s_waitcnt lgkmcnt(0)
    v_cmp_gt_u32 vcc, 1, v31
    s_cbranch_vccz L_fd_45
    s_sub_u32 s68, s68, 1
    s_cbranch_scc0 L_fw_44
L_fd_45:
    v_readfirstlane_b32 s61, v31
    v_mov_b32 v31, 4
    ds_write_b32 v62, v31 offset:24
    s_mul_i32 s64, s54, 49152
    s_mul_i32 s67, s58, 6144
    s_add_u32 s64, s64, s67
    s_add_u32 s64, s64, 524288
    s_add_u32 s65, s64, 4096
    buffer_load_dwordx4 v[160:163], v236, s[4:7], s64 offen sc1
    buffer_load_dwordx4 v[164:167], v236, s[4:7], s64 offen offset:1024 sc1
    buffer_load_dwordx4 v[168:171], v236, s[4:7], s64 offen offset:2048 sc1
    buffer_load_dwordx4 v[172:175], v236, s[4:7], s64 offen offset:3072 sc1
    buffer_load_dwordx4 v[176:179], v236, s[4:7], s65 offen sc1
    buffer_load_dwordx4 v[180:183], v236, s[4:7], s65 offen offset:1024 sc1
    s_mul_i32 s88, s57, 393216
    s_mul_i32 s67, s53, 1536
    s_add_u32 s88, s88, s67
    s_mul_i32 s67, s58, 49152
    s_add_u32 s88, s88, s67
    s_add_u32 s88, s88, 2097152
    s_add_u32 s86, s88, 25088
    v_lshrrev_b32 v15, 5, v1
    v_mul_u32_u24 v15, 23040, v15
    v_add_u32 v15, v15, v30
    s_cmp_eq_u32 s61, 2
    s_cbranch_scc0 L_skip_46
    buffer_store_dwordx4 v[46:49], v30, s[4:7], s88 offen
    buffer_store_dwordx4 v[46:49], v15, s[4:7], s88 offen offset:1024
    buffer_store_dwordx4 v[46:49], v30, s[4:7], s86 offen
    s_branch L_end_47
L_skip_46:
    buffer_store_dwordx4 v[46:49], v30, s[4:7], s88 offen sc1
    buffer_store_dwordx4 v[46:49], v15, s[4:7], s88 offen offset:1024 sc1
    buffer_store_dwordx4 v[46:49], v30, s[4:7], s86 offen sc1
L_end_47:
    s_add_u32 s62, s79, 393216
    s_mov_b32 m0, 98304
    s_waitcnt vmcnt(29)
    buffer_load_dwordx4 v35, s[24:27], s62 offen nt lds
    s_add_u32 m0, m0, 1024
    s_waitcnt vmcnt(29)
    buffer_load_dwordx4 v36, s[24:27], s62 offen nt lds
    s_add_u32 m0, m0, 1024
    s_waitcnt vmcnt(29)
    buffer_load_dwordx4 v37, s[24:27], s62 offen nt lds
    s_add_u32 m0, m0, 1024
    s_add_u32 s62, s62, 98304
    s_waitcnt vmcnt(29)
    buffer_load_dwordx4 v35, s[24:27], s62 offen nt lds
    s_add_u32 m0, m0, 1024
    s_waitcnt vmcnt(29)
    buffer_load_dwordx4 v36, s[24:27], s62 offen nt lds
    s_add_u32 m0, m0, 1024
    s_waitcnt vmcnt(29)
    buffer_load_dwordx4 v37, s[24:27], s62 offen nt lds
    s_add_u32 m0, m0, 1024
    s_add_u32 s62, s62, 98304
    s_waitcnt vmcnt(29)
    buffer_load_dwordx4 v35, s[24:27], s62 offen nt lds
    s_add_u32 m0, m0, 1024
    s_waitcnt vmcnt(29)
    buffer_load_dwordx4 v36, s[24:27], s62 offen nt lds
    s_add_u32 m0, m0, 1024
    s_waitcnt vmcnt(29)
    buffer_load_dwordx4 v37, s[24:27], s62 offen nt lds
    s_add_u32 m0, m0, 1024
    s_add_u32 s62, s62, 98304
    s_waitcnt vmcnt(29)
    buffer_load_dwordx4 v35, s[24:27], s62 offen nt lds
    s_add_u32 m0, m0, 1024
    s_waitcnt vmcnt(29)
    buffer_load_dwordx4 v36, s[24:27], s62 offen nt lds
    s_add_u32 m0, m0, 1024
    s_waitcnt vmcnt(29)
    buffer_load_dwordx4 v37, s[24:27], s62 offen nt lds
    s_add_u32 m0, m0, 1024
    s_add_u32 s62, s62, 98304
    s_waitcnt vmcnt(29)
    buffer_load_dwordx4 v35, s[24:27], s62 offen nt lds
    s_add_u32 m0, m0, 1024
    s_waitcnt vmcnt(29)
    buffer_load_dwordx4 v36, s[24:27], s62 offen nt lds
    s_add_u32 m0, m0, 1024
    s_waitcnt vmcnt(29)
    buffer_load_dwordx4 v37, s[24:27], s62 offen nt lds
    s_add_u32 m0, m0, 1024
    s_add_u32 s62, s62, 98304
    s_waitcnt vmcnt(29)
    buffer_load_dwordx4 v35, s[24:27], s62 offen nt lds
    s_add_u32 m0, m0, 1024
    s_waitcnt vmcnt(29)
    buffer_load_dwordx4 v36, s[24:27], s62 offen nt lds
    s_add_u32 m0, m0, 1024
    s_waitcnt vmcnt(29)
    buffer_load_dwordx4 v37, s[24:27], s62 offen nt lds
    s_add_u32 m0, m0, 1024
    s_add_u32 s62, s62, 98304
    s_waitcnt vmcnt(29)
    buffer_load_dwordx4 v35, s[24:27], s62 offen nt lds
    s_add_u32 m0, m0, 1024
    s_waitcnt vmcnt(29)
    buffer_load_dwordx4 v36, s[24:27], s62 offen nt lds
    s_add_u32 m0, m0, 1024
    s_waitcnt vmcnt(29)
    v_mov_b32 v31, 5
    ds_write_b32 v62, v31 offset:24
    buffer_load_dwordx4 v37, s[24:27], s62 offen nt lds
    ds_read_b128 v[64:67], v200 offset:0
    ds_read_b128 v[76:79], v200 offset:24576
    ds_read_b128 v[88:91], v201 offset:0
    ds_read_b128 v[100:103], v201 offset:24576
    ds_read_b128 v[68:71], v202 offset:0
    ds_read_b128 v[80:83], v202 offset:24576
    ds_read_b128 v[92:95], v203 offset:0
    ds_read_b128 v[104:107], v203 offset:24576
    ds_read_b128 v[72:75], v204 offset:0
    ds_read_b128 v[84:87], v204 offset:24576
    ds_read_b128 v[96:99], v205 offset:0
    ds_read_b128 v[108:111], v205 offset:24576
    ds_read_b64_tr_b16 v[112:113], v206 offset:0
    ds_read_b64_tr_b16 v[114:115], v206 offset:24576
    ds_read_b64_tr_b16 v[136:137], v207 offset:0
    ds_read_b64_tr_b16 v[138:139], v207 offset:24576
    ds_read_b64_tr_b16 v[116:117], v208 offset:0
    ds_read_b64_tr_b16 v[118:119], v208 offset:24576
    ds_read_b64_tr_b16 v[140:141], v209 offset:0
    ds_read_b64_tr_b16 v[142:143], v209 offset:24576
    ds_read_b64_tr_b16 v[120:121], v210 offset:0
    ds_read_b64_tr_b16 v[122:123], v210 offset:24576
    ds_read_b64_tr_b16 v[144:145], v211 offset:0
    ds_read_b64_tr_b16 v[146:147], v211 offset:24576
    ds_read_b64_tr_b16 v[124:125], v212 offset:0
    ds_read_b64_tr_b16 v[126:127], v212 offset:24576
    ds_read_b64_tr_b16 v[148:149], v213 offset:0
    ds_read_b64_tr_b16 v[150:151], v213 offset:24576
    ds_read_b64_tr_b16 v[128:129], v214 offset:0
    ds_read_b64_tr_b16 v[130:131], v214 offset:24576
    ds_read_b64_tr_b16 v[152:153], v215 offset:0
    ds_read_b64_tr_b16 v[154:155], v215 offset:24576
    ds_read_b64_tr_b16 v[132:133], v216 offset:0
    ds_read_b64_tr_b16 v[134:135], v216 offset:24576
    ds_read_b64_tr_b16 v[156:157], v217 offset:0
    ds_read_b64_tr_b16 v[158:159], v217 offset:24576
    v_mov_b32 v31, 1
    s_mov_b64 exec, 1
    ds_add_u32 v62, v31 offset:32
    s_mov_b64 exec, -1
    s_add_u32 m0, m0, 1024
    s_add_u32 s62, s62, 98304
    s_waitcnt vmcnt(29)
    buffer_load_dwordx4 v35, s[24:27], s62 offen nt lds
    s_add_u32 m0, m0, 1024
    s_waitcnt vmcnt(29)
    buffer_load_dwordx4 v36, s[24:27], s62 offen nt lds
    s_add_u32 m0, m0, 1024
    s_waitcnt vmcnt(29)
    buffer_load_dwordx4 v37, s[24:27], s62 offen nt lds
    s_add_u32 m0, m0, 1024
    s_add_u32 s62, s62, 98304
    s_mov_b32 s68, 0x800000
L_fw_48:
    ds_read_b32 v31, v62 offset:32
    s_waitcnt lgkmcnt(0)
    v_cmp_gt_u32 vcc, 8, v31
    s_cbranch_vccz L_fd_49
    s_sub_u32 s68, s68, 1
    s_cbranch_scc0 L_fw_48
L_fd_49:
    s_mov_b32 s62, s79
    s_mov_b32 m0, 86016
    s_waitcnt vmcnt(29)
    buffer_load_dwordx4 v35, s[24:27], s62 offen nt lds
    s_add_u32 m0, m0, 1024
    s_waitcnt vmcnt(29)
    buffer_load_dwordx4 v36, s[24:27], s62 offen nt lds
    s_add_u32 m0, m0, 1024
    s_waitcnt vmcnt(29)
    buffer_load_dwordx4 v37, s[24:27], s62 offen nt lds
    s_add_u32 m0, m0, 1024
    s_add_u32 s62, s62, 98304
    s_waitcnt vmcnt(29)
    buffer_load_dwordx4 v35, s[24:27], s62 offen nt lds
    s_add_u32 m0, m0, 1024
    s_waitcnt vmcnt(29)
    buffer_load_dwordx4 v36, s[24:27], s62 offen nt lds
    s_add_u32 m0, m0, 1024
    s_waitcnt vmcnt(29)
    buffer_load_dwordx4 v37, s[24:27], s62 offen nt lds
    s_add_u32 m0, m0, 1024
    s_add_u32 s62, s62, 98304
    s_waitcnt vmcnt(29)
    buffer_load_dwordx4 v35, s[24:27], s62 offen nt lds
    s_add_u32 m0, m0, 1024
    s_waitcnt vmcnt(29)
    buffer_load_dwordx4 v36, s[24:27], s62 offen nt lds
    s_add_u32 m0, m0, 1024
    s_waitcnt vmcnt(29)
    buffer_load_dwordx4 v37, s[24:27], s62 offen nt lds
    s_add_u32 m0, m0, 1024
    s_add_u32 s62, s62, 98304
    s_waitcnt vmcnt(29)
    buffer_load_dwordx4 v35, s[24:27], s62 offen nt lds
    s_add_u32 m0, m0, 1024
    s_waitcnt vmcnt(29)
    buffer_load_dwordx4 v36, s[24:27], s62 offen nt lds
    s_add_u32 m0, m0, 1024
    s_waitcnt vmcnt(29)
    buffer_load_dwordx4 v37, s[24:27], s62 offen nt lds
    s_add_u32 m0, m0, 1024
    s_add_u32 s62, s62, 98304
    s_mov_b32 s68, 400000
    s_waitcnt vmcnt(36)
    s_branch L_qachk
    s_branch L_s4go
L_s3:
    s_lshl_b32 s62, s58, 5
    v_add_u32 v10, s62, v3
    v_mul_u32_u24 v10, 384, v10
    v_add_u32 v10, 61440, v10
    v_and_b32 v11, 6, v3
    v_xor_b32 v11, v11, v2
    v_xor_b32 v12, 4, v11
    v_lshl_add_u32 v11, v11, 4, v10
    v_lshl_add_u32 v12, v12, 4, v10
    v_and_b32 v10, 1, v2
    v_lshlrev_b32 v53, 10, v10
    v_lshrrev_b32 v10, 1, v2
    v_lshl_add_u32 v53, v10, 5, v53
    v_lshl_add_u32 v53, v3, 1, v53
    v_mov_b32 v10, 0x7fff0000
    v_cndmask_b32 v53, v53, v10, s[72:73]
    s_mul_i32 s62, s55, 12288
    s_mul_i32 s67, s58, 1536
    s_add_u32 s62, s62, s67
    s_add_u32 s62, s62, 8519680
    s_mul_i32 s63, s58, 800
    s_add_u32 s63, s63, 155648
    v_lshl_add_u32 v7, v1, 3, s63
    v_lshlrev_b32 v8, 5, v1
    s_sub_u32 s64, s62, 8388608
    s_cmp_lt_u32 s58, 4
    s_cbranch_scc0 L_skip_50
    s_mov_b32 s68, 0x800000
L_fw_51:
    ds_read_b32 v31, v62 offset:24
    s_waitcnt lgkmcnt(0)
    v_cmp_gt_u32 vcc, 2, v31
    s_cbranch_vccz L_fd_52
    s_sub_u32 s68, s68, 1
    s_cbranch_scc0 L_fw_51
L_fd_52:
    s_cmp_lt_u32 s58, 3
    s_cbranch_scc0 L_skip_53
    ds_read_b128 v[142:145], v11 offset:0
    ds_read_b128 v[146:149], v12 offset:0
    ds_read_b128 v[150:153], v11 offset:128
    ds_read_b128 v[154:157], v12 offset:128
    ds_read_b128 v[158:161], v11 offset:256
    ds_read_b128 v[162:165], v12 offset:256
    ds_read_b128 v[166:169], v11 offset:6144
    ds_read_b128 v[170:173], v12 offset:6144
    ds_read_b128 v[174:177], v11 offset:6272
    ds_read_b128 v[178:181], v12 offset:6272
    ds_read_b128 v[182:185], v11 offset:6400
    ds_read_b128 v[186:189], v12 offset:6400
    v_mov_b32 v31, 1
    s_mov_b64 exec, 1
    ds_add_u32 v62, v31 offset:16
    s_mov_b64 exec, -1
L_skip_53:
    s_mov_b32 s68, 0x800000
L_fw_54:
    ds_read_b32 v31, v62 offset:28
    s_waitcnt lgkmcnt(0)
    v_cmp_gt_u32 vcc, 4, v31
    s_cbranch_vccz L_fd_55
    s_sub_u32 s68, s68, 1
    s_cbranch_scc0 L_fw_54
L_fd_55:
    s_mov_b32 s68, 0x800000
L_fw_56:
    ds_read_b32 v31, v62 offset:24
    s_waitcnt lgkmcnt(0)
    v_cmp_gt_u32 vcc, 3, v31
    s_cbranch_vccz L_fd_57
    s_sub_u32 s68, s68, 1
    s_cbranch_scc0 L_fw_56
L_fd_57:
    s_mov_b32 exec_lo, -1
    s_mov_b32 exec_hi, 0xffff
    s_mov_b32 s68, 400000
L_poll_58:
    s_cmp_ge_u32 s68, 399988
    s_cbranch_scc0 L_skip_61
    buffer_load_dwordx4 v[64:67], v8, s[4:7], s62 offen nt
    buffer_load_dwordx4 v[68:71], v8, s[4:7], s62 offen offset:16 nt
    s_branch L_end_62
L_skip_61:
    buffer_load_dwordx4 v[64:67], v8, s[4:7], s64 offen sc1
    buffer_load_dwordx4 v[68:71], v8, s[4:7], s64 offen offset:16 sc1
L_end_62:
    s_waitcnt vmcnt(0)
    v_xor_b32 v65, s3, v65
    v_xor_b32 v67, s3, v67
    v_xor_b32 v69, s3, v69
    v_xor_b32 v71, s3, v71
    v_or3_b32 v22, v65, v67, v69
    v_or_b32 v22, v22, v71
    v_cmp_ne_u32 vcc, 0, v22
    s_cbranch_vccz L_pdone_59
    s_sleep 1
    s_sub_u32 s68, s68, 1
    s_cbranch_scc0 L_poll_58
L_pdone_59:
    v_cvt_pk_bf16_f32 v22, v64, v66
    v_lshlrev_b32 v65, 16, v22
    v_and_b32 v67, s78, v22
    v_sub_f32 v65, v64, v65
    v_sub_f32 v67, v66, v67
    v_cvt_pk_bf16_f32 v24, v65, v67
    v_cvt_pk_bf16_f32 v23, v68, v70
    v_lshlrev_b32 v69, 16, v23
    v_and_b32 v71, s78, v23
    v_sub_f32 v69, v68, v69
    v_sub_f32 v71, v70, v71
    v_cvt_pk_bf16_f32 v25, v69, v71
    ds_write_b64 v7, v[22:23] offset:0
    ds_write_b64 v7, v[24:25] offset:400
    v_mov_b32 v31, 1
    s_mov_b64 exec, 1
    ds_add_u32 v62, v31 offset:20
    s_mov_b64 exec, -1
    s_branch L_end_63
L_skip_50:
    s_mov_b32 s68, 0x800000
L_fw_64:
    ds_read_b32 v31, v62 offset:12
    s_waitcnt lgkmcnt(0)
    v_cmp_gt_u32 vcc, 2, v31
    s_cbranch_vccz L_fd_65
    s_sub_u32 s68, s68, 1
    s_cbranch_scc0 L_fw_64
L_fd_65:
    s_mov_b32 s68, 0x800000
L_fw_66:
    ds_read_b32 v31, v62 offset:24
    s_waitcnt lgkmcnt(0)
    v_cmp_gt_u32 vcc, 2, v31
    s_cbranch_vccz L_fd_67
    s_sub_u32 s68, s68, 1
    s_cbranch_scc0 L_fw_66
L_fd_67:
    s_cmp_lt_u32 s58, 3
    s_cbranch_scc0 L_skip_68
    ds_read_b128 v[142:145], v11 offset:0
    ds_read_b128 v[146:149], v12 offset:0
    ds_read_b128 v[150:153], v11 offset:128
    ds_read_b128 v[154:157], v12 offset:128
    ds_read_b128 v[158:161], v11 offset:256
    ds_read_b128 v[162:165], v12 offset:256
    ds_read_b128 v[166:169], v11 offset:6144
    ds_read_b128 v[170:173], v12 offset:6144
    ds_read_b128 v[174:177], v11 offset:6272
    ds_read_b128 v[178:181], v12 offset:6272
    ds_read_b128 v[182:185], v11 offset:6400
    ds_read_b128 v[186:189], v12 offset:6400
    v_mov_b32 v31, 1
    s_mov_b64 exec, 1
    ds_add_u32 v62, v31 offset:16
    s_mov_b64 exec, -1
L_skip_68:
    s_mov_b32 s68, 0x800000
L_fw_69:
    ds_read_b32 v31, v62 offset:28
    s_waitcnt lgkmcnt(0)
    v_cmp_gt_u32 vcc, 4, v31
    s_cbranch_vccz L_fd_70
    s_sub_u32 s68, s68, 1
    s_cbranch_scc0 L_fw_69
L_fd_70:
    s_mov_b32 s68, 0x800000
L_fw_71:
    ds_read_b32 v31, v62 offset:24
    s_waitcnt lgkmcnt(0)
    v_cmp_gt_u32 vcc, 3, v31
    s_cbranch_vccz L_fd_72
    s_sub_u32 s68, s68, 1
    s_cbranch_scc0 L_fw_71
L_fd_72:
    s_mov_b32 exec_lo, -1
    s_mov_b32 exec_hi, 0xffff
    s_mov_b32 s68, 400000
L_poll_73:
    s_cmp_ge_u32 s68, 399988
    s_cbranch_scc0 L_skip_76
    buffer_load_dwordx4 v[64:67], v8, s[4:7], s62 offen nt
    buffer_load_dwordx4 v[68:71], v8, s[4:7], s62 offen offset:16 nt
    buffer_load_dwordx4 v[72:75], v8, s[4:7], s62 offen offset:3072 nt
    buffer_load_dwordx4 v[76:79], v8, s[4:7], s62 offen offset:3088 nt
    s_branch L_end_77
L_skip_76:
    buffer_load_dwordx4 v[64:67], v8, s[4:7], s64 offen sc1
    buffer_load_dwordx4 v[68:71], v8, s[4:7], s64 offen offset:16 sc1
    buffer_load_dwordx4 v[72:75], v8, s[4:7], s64 offen offset:3072 sc1
    buffer_load_dwordx4 v[76:79], v8, s[4:7], s64 offen offset:3088 sc1
L_end_77:
    s_waitcnt vmcnt(0)
    v_xor_b32 v65, s3, v65
    v_xor_b32 v67, s3, v67
    v_xor_b32 v69, s3, v69
    v_xor_b32 v71, s3, v71
    v_xor_b32 v73, s3, v73
    v_xor_b32 v75, s3, v75
    v_xor_b32 v77, s3, v77
    v_xor_b32 v79, s3, v79
    v_or3_b32 v22, v65, v67, v69
    v_or3_b32 v22, v22, v71, v73
    v_or3_b32 v22, v22, v75, v77
    v_or_b32 v22, v22, v79
    v_cmp_ne_u32 vcc, 0, v22
    s_cbranch_vccz L_pdone_74
    s_sleep 1
    s_sub_u32 s68, s68, 1
    s_cbranch_scc0 L_poll_73
L_pdone_74:
    v_cvt_pk_bf16_f32 v22, v64, v66
    v_lshlrev_b32 v65, 16, v22
    v_and_b32 v67, s78, v22
    v_sub_f32 v65, v64, v65
    v_sub_f32 v67, v66, v67
    v_cvt_pk_bf16_f32 v24, v65, v67
    v_cvt_pk_bf16_f32 v23, v68, v70
    v_lshlrev_b32 v69, 16, v23
    v_and_b32 v71, s78, v23
    v_sub_f32 v69, v68, v69
    v_sub_f32 v71, v70, v71
    v_cvt_pk_bf16_f32 v25, v69, v71
    ds_write_b64 v7, v[22:23] offset:0
    ds_write_b64 v7, v[24:25] offset:400
    v_cvt_pk_bf16_f32 v22, v72, v74
    v_lshlrev_b32 v73, 16, v22
    v_and_b32 v75, s78, v22
    v_sub_f32 v73, v72, v73
    v_sub_f32 v75, v74, v75
    v_cvt_pk_bf16_f32 v24, v73, v75
    v_cvt_pk_bf16_f32 v23, v76, v78
    v_lshlrev_b32 v77, 16, v23
    v_and_b32 v79, s78, v23
    v_sub_f32 v77, v76, v77
    v_sub_f32 v79, v78, v79
    v_cvt_pk_bf16_f32 v25, v77, v79
    ds_write_b64 v7, v[22:23] offset:1600
    ds_write_b64 v7, v[24:25] offset:2000
    v_mov_b32 v31, 1
    s_mov_b64 exec, 1
    ds_add_u32 v62, v31 offset:20
    s_mov_b64 exec, -1
L_end_63:
    s_cmp_lt_u32 s58, 3
    s_cbranch_scc0 L_skip_78
    s_and_b32 s62, s55, 15
    s_lshl_b32 s62, s62, 6
    s_mul_i32 s67, s54, 49152
    s_add_u32 s62, s62, s67
    s_mul_i32 s67, s56, 6144
    s_add_u32 s62, s62, s67
    s_lshl_b32 s67, s58, 11
    s_add_u32 s62, s62, s67
    s_add_u32 s62, s62, 524288
    s_mov_b32 s68, 0x800000
L_fw_79:
    ds_read_b32 v31, v62 offset:20
    s_waitcnt lgkmcnt(0)
    v_cmp_gt_u32 vcc, 6, v31
    s_cbranch_vccz L_fd_80
    s_sub_u32 s68, s68, 1
    s_cbranch_scc0 L_fw_79
L_fd_80:
    ds_read_b128 v[64:67], v51 offset:0
    ds_read_b128 v[68:71], v51 offset:64
    ds_read_b128 v[72:75], v51 offset:128
    ds_read_b128 v[76:79], v51 offset:192
    ds_read_b128 v[80:83], v51 offset:256
    ds_read_b128 v[84:87], v51 offset:320
    s_waitcnt lgkmcnt(5)
    v_mfma_f32_16x16x32_bf16 v[96:99], v[64:67], v[142:145], 0
    v_mfma_f32_16x16x32_bf16 v[100:103], v[64:67], v[166:169], 0
    s_waitcnt lgkmcnt(4)
    v_mfma_f32_16x16x32_bf16 v[96:99], v[68:71], v[146:149], v[96:99]
    v_mfma_f32_16x16x32_bf16 v[100:103], v[68:71], v[170:173], v[100:103]
    s_waitcnt lgkmcnt(3)
    v_mfma_f32_16x16x32_bf16 v[96:99], v[72:75], v[150:153], v[96:99]
    v_mfma_f32_16x16x32_bf16 v[100:103], v[72:75], v[174:177], v[100:103]
    s_waitcnt lgkmcnt(2)
    v_mfma_f32_16x16x32_bf16 v[96:99], v[76:79], v[154:157], v[96:99]
    v_mfma_f32_16x16x32_bf16 v[100:103], v[76:79], v[178:181], v[100:103]
    s_waitcnt lgkmcnt(1)
    v_mfma_f32_16x16x32_bf16 v[96:99], v[80:83], v[158:161], v[96:99]
    v_mfma_f32_16x16x32_bf16 v[100:103], v[80:83], v[182:185], v[100:103]
    s_waitcnt lgkmcnt(0)
    v_mfma_f32_16x16x32_bf16 v[96:99], v[84:87], v[162:165], v[96:99]
    v_mfma_f32_16x16x32_bf16 v[100:103], v[84:87], v[186:189], v[100:103]
    s_nop 6
    v_add_f32 v96, v96, v97
    v_add_f32 v98, v98, v99
    v_add_f32 v100, v100, v101
    v_add_f32 v102, v102, v103
    v_add_f32 v96, v96, v98
    v_add_f32 v100, v100, v102
    s_nop 1
    v_permlane32_swap_b32 v96, v100
    v_add_f32 v96, v96, v100
    v_mov_b32 v97, v96
    s_nop 1
    v_permlane16_swap_b32 v96, v97
    v_add_f32 v96, v96, v97
    s_nop 1
    v_mov_b32_dpp v97, v96 quad_perm:[1,1,3,3] row_mask:0xf bank_mask:0xf
    v_cvt_pk_bf16_f32 v98, v96, v97
    v_lshlrev_b32 v10, 16, v98
    v_and_b32 v11, s78, v98
    v_sub_f32 v10, v96, v10
    v_sub_f32 v11, v97, v11
    v_cvt_pk_bf16_f32 v99, v10, v11
    v_cndmask_b32 v98, v98, v99, s[84:85]
    buffer_store_dword v98, v53, s[4:7], s62 offen sc1
L_skip_78:
    s_cmp_eq_u32 s58, 4
    s_cbranch_scc0 L_skip_81
    s_cmp_lt_i32 s59, 0
    s_cbranch_scc0 L_skip_82
    s_mov_b32 s68, 0x800000
L_fw_83:
    ds_read_b32 v31, v62 offset:8
    s_waitcnt lgkmcnt(0)
    v_cmp_gt_u32 vcc, 1, v31
    s_cbranch_vccz L_fd_84
    s_sub_u32 s68, s68, 1
    s_cbranch_scc0 L_fw_83
L_fd_84:
    v_readfirstlane_b32 s61, v31
    s_mul_i32 s62, s2, 640
    s_add_u32 s62, s62, -88064
    s_add_u32 s63, s62, 10240
    s_add_u32 s64, s62, 20480
    s_add_u32 s65, s62, 30720
    s_mov_b32 exec_lo, -1
    s_mov_b32 exec_hi, 0xff
    s_mov_b32 s68, 400000
L_poll_85:
    buffer_load_dwordx4 v[64:67], v30, s[4:7], s62 offen sc1
    buffer_load_dwordx4 v[68:71], v30, s[4:7], s63 offen sc1
    buffer_load_dwordx4 v[72:75], v30, s[4:7], s64 offen sc1
    buffer_load_dwordx4 v[76:79], v30, s[4:7], s65 offen sc1
    s_waitcnt vmcnt(0)
    v_max3_u32 v14, v64, v65, v66
    v_max3_u32 v14, v14, v67, v68
    v_max3_u32 v14, v14, v69, v70
    v_max3_u32 v14, v14, v71, v72
    v_max3_u32 v14, v14, v73, v74
    v_max3_u32 v14, v14, v75, v76
    v_max3_u32 v14, v14, v77, v78
    v_max_u32 v14, v14, v79
    v_cmp_eq_u32 vcc, -1, v14
    s_cbranch_vccz L_pdone_86
    s_sleep 8
    s_sub_u32 s68, s68, 1
    s_cbranch_scc0 L_poll_85
L_pdone_86:
    v_pk_add_f32 v[64:65], v[64:65], v[68:69]
    v_pk_add_f32 v[72:73], v[72:73], v[76:77]
    v_pk_add_f32 v[66:67], v[66:67], v[70:71]
    v_pk_add_f32 v[74:75], v[74:75], v[78:79]
    v_pk_add_f32 v[64:65], v[64:65], v[72:73]
    v_pk_add_f32 v[66:67], v[66:67], v[74:75]
    s_add_u32 s62, s62, 49152
    buffer_store_dwordx4 v[64:67], v30, s[4:7], s62 offen sc1
    s_mov_b64 exec, -1
L_skip_82:
L_skip_81:
L_s4go:
    s_mul_i32 s64, s54, 49152
    s_mul_i32 s67, s58, 6144
    s_add_u32 s64, s64, s67
    s_add_u32 s64, s64, 524288
    s_add_u32 s65, s64, 4096
    s_mov_b32 s68, 0x800000
L_fw_88:
    ds_read_b32 v31, v62 offset:8
    s_waitcnt lgkmcnt(0)
    v_cmp_gt_u32 vcc, 1, v31
    s_cbranch_vccz L_fd_89
    s_sub_u32 s68, s68, 1
    s_cbranch_scc0 L_fw_88
L_fd_89:
    v_readfirstlane_b32 s61, v31
    s_mov_b32 s68, 0x800000
L_fw_90:
    ds_read_b32 v31, v62 offset:24
    s_waitcnt lgkmcnt(0)
    v_cmp_gt_u32 vcc, 4, v31
    s_cbranch_vccz L_fd_91
    s_sub_u32 s68, s68, 1
    s_cbranch_scc0 L_fw_90
L_fd_91:
    buffer_load_dwordx4 v[160:163], v236, s[4:7], s64 offen sc1
    buffer_load_dwordx4 v[164:167], v236, s[4:7], s64 offen offset:1024 sc1
    buffer_load_dwordx4 v[168:171], v236, s[4:7], s64 offen offset:2048 sc1
    buffer_load_dwordx4 v[172:175], v236, s[4:7], s64 offen offset:3072 sc1
    buffer_load_dwordx4 v[176:179], v236, s[4:7], s65 offen sc1
    buffer_load_dwordx4 v[180:183], v236, s[4:7], s65 offen offset:1024 sc1
    s_mul_i32 s88, s57, 393216
    s_mul_i32 s67, s53, 1536
    s_add_u32 s88, s88, s67
    s_mul_i32 s67, s58, 49152
    s_add_u32 s88, s88, s67
    s_add_u32 s88, s88, 2097152
    s_add_u32 s86, s88, 25088
    v_lshrrev_b32 v15, 5, v1
    v_mul_u32_u24 v15, 23040, v15
    v_add_u32 v15, v15, v30
    s_cmp_eq_u32 s61, 2
    s_cbranch_scc0 L_skip_92
    buffer_store_dwordx4 v[46:49], v30, s[4:7], s88 offen
    buffer_store_dwordx4 v[46:49], v15, s[4:7], s88 offen offset:1024
    buffer_store_dwordx4 v[46:49], v30, s[4:7], s86 offen
    s_branch L_end_93
L_skip_92:
    buffer_store_dwordx4 v[46:49], v30, s[4:7], s88 offen sc1
    buffer_store_dwordx4 v[46:49], v15, s[4:7], s88 offen offset:1024 sc1
    buffer_store_dwordx4 v[46:49], v30, s[4:7], s86 offen sc1
L_end_93:
    s_mov_b32 s68, 0x800000
L_fw_94:
    ds_read_b32 v31, v62 offset:24
    s_waitcnt lgkmcnt(0)
    v_cmp_gt_u32 vcc, 5, v31
    s_cbranch_vccz L_fd_95
    s_sub_u32 s68, s68, 1
    s_cbranch_scc0 L_fw_94
L_fd_95:
    ds_read_b128 v[64:67], v200 offset:0
    ds_read_b128 v[76:79], v200 offset:24576
    ds_read_b128 v[88:91], v201 offset:0
    ds_read_b128 v[100:103], v201 offset:24576
    ds_read_b128 v[68:71], v202 offset:0
    ds_read_b128 v[80:83], v202 offset:24576
    ds_read_b128 v[92:95], v203 offset:0
    ds_read_b128 v[104:107], v203 offset:24576
    ds_read_b128 v[72:75], v204 offset:0
    ds_read_b128 v[84:87], v204 offset:24576
    ds_read_b128 v[96:99], v205 offset:0
    ds_read_b128 v[108:111], v205 offset:24576
    ds_read_b64_tr_b16 v[112:113], v206 offset:0
    ds_read_b64_tr_b16 v[114:115], v206 offset:24576
    ds_read_b64_tr_b16 v[136:137], v207 offset:0
    ds_read_b64_tr_b16 v[138:139], v207 offset:24576
    ds_read_b64_tr_b16 v[116:117], v208 offset:0
    ds_read_b64_tr_b16 v[118:119], v208 offset:24576
    ds_read_b64_tr_b16 v[140:141], v209 offset:0
    ds_read_b64_tr_b16 v[142:143], v209 offset:24576
    ds_read_b64_tr_b16 v[120:121], v210 offset:0
    ds_read_b64_tr_b16 v[122:123], v210 offset:24576
    ds_read_b64_tr_b16 v[144:145], v211 offset:0
    ds_read_b64_tr_b16 v[146:147], v211 offset:24576
    ds_read_b64_tr_b16 v[124:125], v212 offset:0
    ds_read_b64_tr_b16 v[126:127], v212 offset:24576
    ds_read_b64_tr_b16 v[148:149], v213 offset:0
    ds_read_b64_tr_b16 v[150:151], v213 offset:24576
    ds_read_b64_tr_b16 v[128:129], v214 offset:0
    ds_read_b64_tr_b16 v[130:131], v214 offset:24576
    ds_read_b64_tr_b16 v[152:153], v215 offset:0
    ds_read_b64_tr_b16 v[154:155], v215 offset:24576
    ds_read_b64_tr_b16 v[132:133], v216 offset:0
    ds_read_b64_tr_b16 v[134:135], v216 offset:24576
    ds_read_b64_tr_b16 v[156:157], v217 offset:0
    ds_read_b64_tr_b16 v[158:159], v217 offset:24576
    v_mov_b32 v31, 1
    s_mov_b64 exec, 1
    ds_add_u32 v62, v31 offset:32
    s_mov_b64 exec, -1
    s_add_u32 s63, s58, 16
    s_cmp_ge_u32 s63, 12
    s_cselect_b32 s62, 12, 0
    s_sub_u32 s63, s63, s62
    s_mul_i32 s62, s63, 98304
    s_add_u32 s62, s62, s79
    s_mul_i32 s63, s63, 3072
    s_add_u32 s63, s63, 86016
    v_lshrrev_b32 v15, 2, v1
    v_lshlrev_b32 v15, 10, v15
    v_lshl_add_u32 v15, v5, 4, v15
    s_lshl_b32 s67, s53, 6
    v_add_u32 v15, s67, v15
    s_mov_b32 s68, 400000
    s_waitcnt vmcnt(0)
    s_branch L_qachk
L_poll_96:
    buffer_load_dwordx4 v[160:163], v236, s[4:7], s64 offen sc1
    buffer_load_dwordx4 v[164:167], v236, s[4:7], s64 offen offset:1024 sc1
    buffer_load_dwordx4 v[168:171], v236, s[4:7], s64 offen offset:2048 sc1
    buffer_load_dwordx4 v[172:175], v236, s[4:7], s64 offen offset:3072 sc1
    buffer_load_dwordx4 v[176:179], v236, s[4:7], s65 offen sc1
    buffer_load_dwordx4 v[180:183], v236, s[4:7], s65 offen offset:1024 sc1
    s_waitcnt vmcnt(0)
L_qachk:
    v_max3_u32 v14, v160, v161, v162
    v_max3_u32 v14, v14, v163, v164
    v_max3_u32 v14, v14, v165, v166
    v_max3_u32 v14, v14, v167, v168
    v_max3_u32 v14, v14, v169, v170
    v_max3_u32 v14, v14, v171, v172
    v_max3_u32 v14, v14, v173, v174
    v_max3_u32 v14, v14, v175, v176
    v_max3_u32 v14, v14, v177, v178
    v_max3_u32 v14, v14, v179, v180
    v_max3_u32 v14, v14, v181, v182
    v_max_u32 v14, v14, v183
    v_cmp_eq_u32 vcc, -1, v14
    s_cbranch_vccz L_pdone_97
    s_sub_u32 s68, s68, 1
    s_cbranch_scc0 L_poll_96
L_pdone_97:
    s_waitcnt lgkmcnt(0)
    ds_read_b32 v31, v62 offset:32
    v_mfma_f32_16x16x32_bf16 v[184:187], v[64:67], v[160:163], 0
    v_mfma_f32_16x16x32_bf16 v[184:187], v[64:67], v[164:167], v[184:187]
    v_mfma_f32_16x16x32_bf16 v[184:187], v[68:71], v[168:171], v[184:187]
    v_mfma_f32_16x16x32_bf16 v[184:187], v[68:71], v[172:175], v[184:187]
    v_mfma_f32_16x16x32_bf16 v[184:187], v[72:75], v[176:179], v[184:187]
    v_mfma_f32_16x16x32_bf16 v[184:187], v[72:75], v[180:183], v[184:187]
    s_waitcnt lgkmcnt(0)
    v_cmp_gt_u32 vcc, 8, v31
    s_cbranch_vccz L_frok
    s_mov_b32 s68, 0x800000
L_fw_98:
    ds_read_b32 v31, v62 offset:32
    s_waitcnt lgkmcnt(0)
    v_cmp_gt_u32 vcc, 8, v31
    s_cbranch_vccz L_fd_99
    s_sub_u32 s68, s68, 1
    s_cbranch_scc0 L_fw_98
L_fd_99:
L_frok:
    v_mfma_f32_16x16x32_bf16 v[188:191], v[76:79], v[160:163], 0
    v_mfma_f32_16x16x32_bf16 v[188:191], v[76:79], v[164:167], v[188:191]
    v_mfma_f32_16x16x32_bf16 v[188:191], v[80:83], v[168:171], v[188:191]
    v_mfma_f32_16x16x32_bf16 v[188:191], v[80:83], v[172:175], v[188:191]
    v_mfma_f32_16x16x32_bf16 v[188:191], v[84:87], v[176:179], v[188:191]
    v_mfma_f32_16x16x32_bf16 v[188:191], v[84:87], v[180:183], v[188:191]
    s_cmp_lt_u32 s56, 5
    s_cbranch_scc0 L_skip_100
    s_and_b32 s86, s58, 1
    s_lshl_b32 s86, s86, 2
    v_add_u32 v24, s86, v2
    v_lshlrev_b32 v24, 1, v24
    v_xor_b32 v24, v24, v3
    v_mul_u32_u24 v25, 1280, v2
    v_lshl_add_u32 v24, v24, 4, v25
    s_mul_i32 s88, s55, 245760
    s_mul_i32 s67, s58, 5120
    s_add_u32 s88, s88, s67
    s_lshl_b32 s67, s56, 8
    s_add_u32 s88, s88, s67
    s_lshl_b32 s86, s58, 10
    s_mov_b32 m0, s86
    s_nop 0
    buffer_load_dwordx4 v24, s[28:31], s88 offen nt lds
    s_add_u32 m0, m0, 8192
    s_add_u32 s88, s88, 40960
    buffer_load_dwordx4 v24, s[28:31], s88 offen nt lds
    s_add_u32 m0, m0, 8192
    s_add_u32 s88, s88, 40960
    s_branch L_end_101
L_skip_100:
    s_cmp_ge_i32 s60, 0
    s_cbranch_scc0 L_skip_102
    v_lshrrev_b32 v24, 2, v1
    v_mul_u32_u24 v24, 3072, v24
    v_lshl_add_u32 v24, v5, 4, v24
    s_mul_i32 s88, s58, 49152
    s_lshl_b32 s67, s60, 6
    s_add_u32 s88, s88, s67
    s_lshl_b32 s86, s58, 10
    s_mov_b32 m0, s86
    s_nop 0
    buffer_load_dwordx4 v24, s[32:35], s88 offen nt lds
    s_add_u32 m0, m0, 8192
    s_add_u32 s88, s88, 393216
    buffer_load_dwordx4 v24, s[32:35], s88 offen nt lds
    s_add_u32 m0, m0, 8192
    s_add_u32 s88, s88, 393216
L_skip_102:
L_end_101:
    ds_write_b128 v237, v[184:187] offset:0
    v_mfma_f32_16x16x32_bf16 v[192:195], v[88:91], v[160:163], 0
    v_mfma_f32_16x16x32_bf16 v[192:195], v[88:91], v[164:167], v[192:195]
    v_mfma_f32_16x16x32_bf16 v[192:195], v[92:95], v[168:171], v[192:195]
    v_mfma_f32_16x16x32_bf16 v[192:195], v[92:95], v[172:175], v[192:195]
    v_mfma_f32_16x16x32_bf16 v[192:195], v[96:99], v[176:179], v[192:195]
    v_mfma_f32_16x16x32_bf16 v[192:195], v[96:99], v[180:183], v[192:195]
    ds_write_b128 v237, v[188:191] offset:1024
    v_mfma_f32_16x16x32_bf16 v[196:199], v[100:103], v[160:163], 0
    v_mfma_f32_16x16x32_bf16 v[196:199], v[100:103], v[164:167], v[196:199]
    v_mfma_f32_16x16x32_bf16 v[196:199], v[104:107], v[168:171], v[196:199]
    v_mfma_f32_16x16x32_bf16 v[196:199], v[104:107], v[172:175], v[196:199]
    v_mfma_f32_16x16x32_bf16 v[196:199], v[108:111], v[176:179], v[196:199]
    v_mfma_f32_16x16x32_bf16 v[196:199], v[108:111], v[180:183], v[196:199]
    s_nop 0
    ds_write_b128 v237, v[192:195] offset:2048
    s_nop 5
    ds_write_b128 v237, v[196:199] offset:3072
    s_waitcnt lgkmcnt(0)
    s_barrier
    ds_read_b64 v[64:65], v238 offset:0
    ds_read_b64 v[66:67], v238 offset:4096
    ds_read_b64 v[68:69], v238 offset:8192
    ds_read_b64 v[70:71], v238 offset:12288
    ds_read_b64 v[72:73], v238 offset:16384
    ds_read_b64 v[74:75], v238 offset:20480
    ds_read_b64 v[76:77], v238 offset:24576
    ds_read_b64 v[78:79], v238 offset:28672
    v_mov_b32 v40, 0x7fff0000
    v_mov_b32 v41, 0x7fff0000
    v_mov_b32 v42, 0x7fff0000
    s_waitcnt lgkmcnt(6)
    v_pk_add_f32 v[64:65], v[64:65], v[66:67]
    s_waitcnt lgkmcnt(4)
    v_pk_add_f32 v[68:69], v[68:69], v[70:71]
    s_waitcnt lgkmcnt(2)
    v_pk_add_f32 v[72:73], v[72:73], v[74:75]
    s_waitcnt lgkmcnt(0)
    v_pk_add_f32 v[76:77], v[76:77], v[78:79]
    v_pk_add_f32 v[64:65], v[64:65], v[68:69]
    v_pk_add_f32 v[72:73], v[72:73], v[76:77]
    v_pk_add_f32 v[64:65], v[64:65], v[72:73]
    v_max_f32 v14, v64, v65
    v_mov_b32 v15, v14
    s_nop 1
    v_permlane16_swap_b32 v14, v15
    v_max_f32 v14, v14, v15
    v_mov_b32 v15, v14
    s_nop 1
    v_permlane32_swap_b32 v14, v15
    v_max_f32 v14, v14, v15
    ds_write_b32 v239, v14
    v_mov_b32 v160, 0x3f803f80
    v_mov_b32 v161, 0x3f803f80
    v_mov_b32 v162, 0x3f803f80
    v_mov_b32 v163, 0x3f803f80
    s_waitcnt lgkmcnt(0)
    s_barrier
    ds_read_b128 v[14:17], v240
    ds_read_b128 v[18:21], v240 offset:16
    s_waitcnt lgkmcnt(1)
    v_max3_f32 v14, v14, v15, v16
    s_waitcnt lgkmcnt(0)
    v_max3_f32 v18, v18, v19, v20
    v_max3_f32 v14, v14, v17, v21
    v_max_f32 v28, v14, v18
    v_sub_f32 v64, v64, v28
    v_sub_f32 v65, v65, v28
    v_mul_f32 v64, s75, v64
    v_mul_f32 v65, s75, v65
    v_exp_f32 v64, v64
    v_exp_f32 v65, v65
    s_nop 0
    v_cvt_pk_bf16_f32 v64, v64, v65
    ds_write_b32 v241, v64
    v_lshlrev_b32 v14, 8, v1
    s_lshl_b32 s62, s57, 12
    s_lshl_b32 s67, s53, 4
    s_add_u32 s62, s62, s67
    s_add_u32 s62, s62, 1048576
    v_mov_b32 v18, v28
    v_mov_b32 v20, s3
    v_mov_b32 v21, s3
    s_lshl_b32 s64, s57, 4
    s_add_u32 s64, s64, s53
    s_lshl_b32 s63, s64, 8
    s_add_u32 s63, s63, 1048576
    s_mul_i32 s65, s64, 24576
    s_mul_i32 s67, s58, 3072
    s_add_u32 s65, s65, s67
    s_add_u32 s65, s65, 2097152
    v_lshlrev_b32 v6, 6, v2
    s_waitcnt lgkmcnt(0)
    s_barrier
    ds_read_b128 v[228:231], v242
    ds_read_b128 v[232:235], v242 offset:1024
    s_waitcnt lgkmcnt(0)
    s_cmp_eq_u32 s58, 0
    s_cbranch_scc0 L_skip_103
    v_mfma_f32_16x16x32_bf16 v[224:227], v[160:163], v[228:231], 0
    v_mfma_f32_16x16x32_bf16 v[224:227], v[160:163], v[232:235], v[224:227]
L_skip_103:
    v_mfma_f32_16x16x32_bf16 v[200:203], v[112:115], v[228:231], 0
    v_mfma_f32_16x16x32_bf16 v[200:203], v[136:139], v[232:235], v[200:203]
    v_mfma_f32_16x16x32_bf16 v[204:207], v[116:119], v[228:231], 0
    v_mfma_f32_16x16x32_bf16 v[204:207], v[140:143], v[232:235], v[204:207]
    s_cmp_eq_u32 s58, 0
    s_nop 1
    s_cbranch_scc0 L_skip_104
    s_nop 1
    v_mov_b32 v19, v224
    s_mov_b32 exec_lo, 0xffff
    s_mov_b32 exec_hi, 0
    s_cmp_eq_u32 s61, 2
    s_cbranch_scc0 L_skip_105
    buffer_store_dwordx4 v[18:21], v14, s[4:7], s62 offen
    s_branch L_end_106
L_skip_105:
    buffer_store_dwordx4 v[18:21], v14, s[4:7], s62 offen sc1
L_end_106:
    s_mov_b64 exec, -1
L_skip_104:
    v_mfma_f32_16x16x32_bf16 v[208:211], v[120:123], v[228:231], 0
    v_mfma_f32_16x16x32_bf16 v[208:211], v[144:147], v[232:235], v[208:211]
    v_cvt_pk_bf16_f32 v200, v200, v201
    v_cvt_pk_bf16_f32 v201, v202, v203
    ds_write_b64 v243, v[200:201] offset:0
    v_mfma_f32_16x16x32_bf16 v[212:215], v[124:127], v[228:231], 0
    v_mfma_f32_16x16x32_bf16 v[212:215], v[148:151], v[232:235], v[212:215]
    v_cvt_pk_bf16_f32 v204, v204, v205
    v_cvt_pk_bf16_f32 v205, v206, v207
    ds_write_b64 v243, v[204:205] offset:32
    v_mfma_f32_16x16x32_bf16 v[216:219], v[128:131], v[228:231], 0
    v_mfma_f32_16x16x32_bf16 v[216:219], v[152:155], v[232:235], v[216:219]
    v_cvt_pk_bf16_f32 v208, v208, v209
    v_cvt_pk_bf16_f32 v209, v210, v211
    ds_write_b64 v243, v[208:209] offset:64
    v_mfma_f32_16x16x32_bf16 v[220:223], v[132:135], v[228:231], 0
    v_mfma_f32_16x16x32_bf16 v[220:223], v[156:159], v[232:235], v[220:223]
    v_cvt_pk_bf16_f32 v212, v212, v213
    v_cvt_pk_bf16_f32 v213, v214, v215
    ds_write_b64 v243, v[212:213] offset:96
    v_cvt_pk_bf16_f32 v216, v216, v217
    v_cvt_pk_bf16_f32 v217, v218, v219
    ds_write_b64 v243, v[216:217] offset:128
    s_nop 1
    v_cvt_pk_bf16_f32 v220, v220, v221
    v_cvt_pk_bf16_f32 v221, v222, v223
    ds_write_b64 v243, v[220:221] offset:160
    ds_read_b128 v[64:67], v244 offset:0
    ds_read_b128 v[68:71], v245 offset:1024
    ds_read_b128 v[72:75], v246 offset:2048
    s_cmp_eq_u32 s61, 2
    s_cbranch_scc0 L_skip_107
    buffer_load_dwordx4 v[92:95], v6, s[4:7], s63 offen nt
    buffer_load_dwordx4 v[96:99], v6, s[4:7], s63 offen offset:16 nt
    buffer_load_dwordx4 v[100:103], v6, s[4:7], s63 offen offset:32 nt
    buffer_load_dwordx4 v[104:107], v6, s[4:7], s63 offen offset:48 nt
    s_branch L_end_108
L_skip_107:
    buffer_load_dwordx4 v[92:95], v6, s[4:7], s63 offen sc1
    buffer_load_dwordx4 v[96:99], v6, s[4:7], s63 offen offset:16 sc1
    buffer_load_dwordx4 v[100:103], v6, s[4:7], s63 offen offset:32 sc1
    buffer_load_dwordx4 v[104:107], v6, s[4:7], s63 offen offset:48 sc1
L_end_108:
    s_waitcnt lgkmcnt(0)
    s_cmp_eq_u32 s61, 2
    s_cbranch_scc0 L_skip_109
    buffer_store_dwordx4 v[64:67], v32, s[4:7], s74 offen
    buffer_store_dwordx4 v[68:71], v33, s[4:7], s74 offen
    buffer_store_dwordx4 v[72:75], v34, s[4:7], s74 offen
    s_branch L_end_110
L_skip_109:
    buffer_store_dwordx4 v[64:67], v32, s[4:7], s74 offen sc1
    buffer_store_dwordx4 v[68:71], v33, s[4:7], s74 offen sc1
    buffer_store_dwordx4 v[72:75], v34, s[4:7], s74 offen sc1
L_end_110:
    s_mul_i32 s64, s58, 3136
    s_add_u32 s64, s64, 49152
    v_add_u32 v7, s64, v30
    v_lshrrev_b32 v8, 5, v1
    v_lshl_add_u32 v8, v8, 5, v7
    v_lshl_add_u32 v9, v2, 2, v4
    v_mul_u32_u24 v9, 1568, v9
    v_lshl_add_u32 v9, v5, 3, v9
    s_mul_i32 s64, s58, 192
    s_add_u32 s64, s64, 49152
    v_add_u32 v9, s64, v9
    v_lshlrev_b32 v10, 2, v1
    s_mov_b32 s68, 400000
    s_waitcnt vmcnt(3)
    s_branch L_pchk_113
L_poll_111:
    s_cmp_eq_u32 s61, 2
    s_cbranch_scc0 L_skip_114
    buffer_load_dwordx4 v[92:95], v6, s[4:7], s63 offen nt
    buffer_load_dwordx4 v[96:99], v6, s[4:7], s63 offen offset:16 nt
    buffer_load_dwordx4 v[100:103], v6, s[4:7], s63 offen offset:32 nt
    buffer_load_dwordx4 v[104:107], v6, s[4:7], s63 offen offset:48 nt
    s_branch L_end_115
L_skip_114:
    buffer_load_dwordx4 v[92:95], v6, s[4:7], s63 offen sc1
    buffer_load_dwordx4 v[96:99], v6, s[4:7], s63 offen offset:16 sc1
    buffer_load_dwordx4 v[100:103], v6, s[4:7], s63 offen offset:32 sc1
    buffer_load_dwordx4 v[104:107], v6, s[4:7], s63 offen offset:48 sc1
L_end_115:
    s_waitcnt vmcnt(0)
L_pchk_113:
    v_xor_b32 v94, s3, v94
    v_xor_b32 v98, s3, v98
    v_xor_b32 v102, s3, v102
    v_xor_b32 v106, s3, v106
    v_or3_b32 v14, v94, v98, v102
    v_or_b32 v14, v14, v106
    v_cmp_ne_u32 vcc, 0, v14
    s_cbranch_vccz L_pdone_112
    s_sub_u32 s68, s68, 1
    s_cbranch_scc0 L_poll_111
L_pdone_112:
    s_cmp_eq_u32 s61, 2
    s_cbranch_scc0 L_skip_116
    buffer_load_dwordx4 v[80:83], v30, s[4:7], s65 offen nt
    buffer_load_dwordx4 v[84:87], v30, s[4:7], s65 offen offset:1024 nt
    buffer_load_dwordx4 v[88:91], v30, s[4:7], s65 offen offset:2048 nt
    s_branch L_end_117
L_skip_116:
    buffer_load_dwordx4 v[80:83], v30, s[4:7], s65 offen sc1
    buffer_load_dwordx4 v[84:87], v30, s[4:7], s65 offen offset:1024 sc1
    buffer_load_dwordx4 v[88:91], v30, s[4:7], s65 offen offset:2048 sc1
L_end_117:
    v_max3_f32 v14, v92, v96, v100
    v_max_f32 v14, v14, v104
    v_mov_b32 v15, v14
    s_nop 1
    v_permlane16_swap_b32 v14, v15
    v_max_f32 v14, v14, v15
    v_mov_b32 v15, v14
    s_nop 1
    v_permlane32_swap_b32 v14, v15
    v_max_f32 v14, v14, v15
    v_sub_f32 v92, v92, v14
    v_sub_f32 v96, v96, v14
    v_sub_f32 v100, v100, v14
    v_sub_f32 v104, v104, v14
    v_mul_f32 v92, s75, v92
    v_mul_f32 v96, s75, v96
    v_mul_f32 v100, s75, v100
    v_mul_f32 v104, s75, v104
    v_exp_f32 v92, v92
    v_exp_f32 v96, v96
    v_exp_f32 v100, v100
    v_exp_f32 v104, v104
    v_cvt_pk_bf16_f32 v16, v92, v96
    v_lshlrev_b32 v20, 16, v16
    v_and_b32 v21, s78, v16
    v_sub_f32 v20, v92, v20
    v_sub_f32 v21, v96, v21
    v_cvt_pk_bf16_f32 v18, v20, v21
    v_cvt_pk_bf16_f32 v17, v100, v104
    v_lshlrev_b32 v22, 16, v17
    v_and_b32 v23, s78, v17
    v_sub_f32 v22, v100, v22
    v_sub_f32 v23, v104, v23
    v_cvt_pk_bf16_f32 v19, v22, v23
    v_cndmask_b32 v16, v16, v18, s[72:73]
    v_cndmask_b32 v17, v17, v19, s[72:73]
    v_mul_f32 v15, v92, v93
    v_fmac_f32 v15, v96, v97
    v_fmac_f32 v15, v100, v101
    v_fmac_f32 v15, v104, v105
    v_mov_b32 v18, v15
    s_nop 1
    v_permlane16_swap_b32 v15, v18
    v_add_f32 v15, v15, v18
    v_mov_b32 v18, v15
    s_nop 1
    v_permlane32_swap_b32 v15, v18
    v_add_f32 v15, v15, v18
    s_mov_b32 s68, 400000
    s_waitcnt vmcnt(0)
    s_branch L_pchk_120
L_poll_118:
    s_cmp_eq_u32 s61, 2
    s_cbranch_scc0 L_skip_121
    buffer_load_dwordx4 v[80:83], v30, s[4:7], s65 offen nt
    buffer_load_dwordx4 v[84:87], v30, s[4:7], s65 offen offset:1024 nt
    buffer_load_dwordx4 v[88:91], v30, s[4:7], s65 offen offset:2048 nt
    s_branch L_end_122
L_skip_121:
    buffer_load_dwordx4 v[80:83], v30, s[4:7], s65 offen sc1
    buffer_load_dwordx4 v[84:87], v30, s[4:7], s65 offen offset:1024 sc1
    buffer_load_dwordx4 v[88:91], v30, s[4:7], s65 offen offset:2048 sc1
L_end_122:
    s_waitcnt vmcnt(0)
L_pchk_120:
    v_max3_u32 v18, v80, v81, v82
    v_max3_u32 v18, v18, v83, v84
    v_max3_u32 v18, v18, v85, v86
    v_max3_u32 v18, v18, v87, v88
    v_max3_u32 v18, v18, v89, v90
    v_max_u32 v18, v18, v91
    v_cmp_eq_u32 vcc, -1, v18
    s_cbranch_vccz L_pdone_119
    s_sub_u32 s68, s68, 1
    s_cbranch_scc0 L_poll_118
L_pdone_119:
    ds_write_b128 v7, v[80:83]
    ds_write_b128 v8, v[84:87] offset:1024
    ds_write_b128 v7, v[88:91] offset:2080
    s_lshl_b32 s64, s54, 4
    s_add_u32 s64, s64, s53
    s_mul_i32 s65, s64, 24576
    s_mul_i32 s67, s58, 3072
    s_add_u32 s65, s65, s67
    s_mul_i32 s67, s52, 384
    s_add_u32 s65, s65, s67
    s_add_u32 s65, s65, 1179648
    s_waitcnt lgkmcnt(0)
    s_barrier
    ds_read_b64_tr_b16 v[64:65], v9 offset:0
    ds_read_b64_tr_b16 v[66:67], v9 offset:32
    ds_read_b64_tr_b16 v[68:69], v9 offset:64
    ds_read_b64_tr_b16 v[70:71], v9 offset:96
    ds_read_b64_tr_b16 v[72:73], v9 offset:128
    ds_read_b64_tr_b16 v[74:75], v9 offset:160
    s_waitcnt lgkmcnt(5)
    v_mfma_f32_16x16x16_bf16 v[100:103], v[16:17], v[64:65], 0
    s_waitcnt lgkmcnt(4)
    v_mfma_f32_16x16x16_bf16 v[104:107], v[16:17], v[66:67], 0
    s_waitcnt lgkmcnt(3)
    v_mfma_f32_16x16x16_bf16 v[108:111], v[16:17], v[68:69], 0
    s_waitcnt lgkmcnt(2)
    v_mfma_f32_16x16x16_bf16 v[112:115], v[16:17], v[70:71], 0
    s_waitcnt lgkmcnt(1)
    v_mfma_f32_16x16x16_bf16 v[116:119], v[16:17], v[72:73], 0
    s_waitcnt lgkmcnt(0)
    v_mfma_f32_16x16x16_bf16 v[120:123], v[16:17], v[74:75], 0
    v_add_f32 v100, v100, v101
    v_add_f32 v104, v104, v105
    v_add_f32 v108, v108, v109
    s_nop 0
    v_add_f32 v112, v112, v113
    s_nop 0
    v_add_f32 v116, v116, v117
    s_nop 0
    v_add_f32 v120, v120, v121
    v_cndmask_b32 v100, v100, v104, s[84:85]
    v_cndmask_b32 v108, v108, v112, s[84:85]
    v_cndmask_b32 v116, v116, v120, s[84:85]
    v_cndmask_b32 v100, v100, v108, s[82:83]
    buffer_store_dword v100, v10, s[4:7], s65 offen sc1
    s_mov_b32 exec_lo, -1
    s_mov_b32 exec_hi, 0
    buffer_store_dword v116, v10, s[4:7], s65 offen offset:256 sc1
    s_cmp_eq_u32 s58, 7
    s_cbranch_scc0 L_skip_123
    s_lshl_b32 s65, s64, 10
    s_lshl_b32 s67, s52, 7
    s_add_u32 s65, s65, s67
    s_add_u32 s65, s65, 1114112
    s_mov_b64 exec, 1
    buffer_store_dwordx2 v[14:15], v10, s[4:7], s65 offen sc1
L_skip_123:
    s_mov_b64 exec, -1
    s_cmp_lt_u32 s56, 5
    s_cbranch_scc0 L_skip_124
    s_and_b32 s86, s58, 1
    s_lshl_b32 s86, s86, 2
    v_add_u32 v24, s86, v2
    v_lshlrev_b32 v24, 1, v24
    v_xor_b32 v24, v24, v3
    v_mul_u32_u24 v25, 1280, v2
    v_lshl_add_u32 v24, v24, 4, v25
    s_mul_i32 s88, s55, 245760
    s_mul_i32 s67, s58, 5120
    s_add_u32 s88, s88, s67
    s_lshl_b32 s67, s56, 8
    s_add_u32 s88, s88, s67
    s_add_u32 s88, s88, 81920
    s_lshl_b32 s86, s58, 10
    s_add_u32 s86, s86, 16384
    s_mov_b32 m0, s86
    s_nop 0
    buffer_load_dwordx4 v24, s[28:31], s88 offen nt lds
    s_add_u32 m0, m0, 8192
    s_add_u32 s88, s88, 40960
    buffer_load_dwordx4 v24, s[28:31], s88 offen nt lds
    s_add_u32 m0, m0, 8192
    s_add_u32 s88, s88, 40960
    buffer_load_dwordx4 v24, s[28:31], s88 offen nt lds
    s_add_u32 m0, m0, 8192
    s_add_u32 s88, s88, 40960
    buffer_load_dwordx4 v24, s[28:31], s88 offen nt lds
    s_add_u32 m0, m0, 8192
    s_add_u32 s88, s88, 40960
    s_branch L_end_125
L_skip_124:
    s_cmp_ge_i32 s60, 0
    s_cbranch_scc0 L_skip_126
    v_lshrrev_b32 v24, 2, v1
    v_mul_u32_u24 v24, 3072, v24
    v_lshl_add_u32 v24, v5, 4, v24
    s_mul_i32 s88, s58, 49152
    s_lshl_b32 s67, s60, 6
    s_add_u32 s88, s88, s67
    s_add_u32 s88, s88, 786432
    s_lshl_b32 s86, s58, 10
    s_add_u32 s86, s86, 16384
    s_mov_b32 m0, s86
    s_nop 0
    buffer_load_dwordx4 v24, s[32:35], s88 offen nt lds
    s_add_u32 m0, m0, 8192
    s_add_u32 s88, s88, 393216
    buffer_load_dwordx4 v24, s[32:35], s88 offen nt lds
    s_add_u32 m0, m0, 8192
    s_add_u32 s88, s88, 393216
    buffer_load_dwordx4 v24, s[32:35], s88 offen nt lds
    s_add_u32 m0, m0, 8192
    s_add_u32 s88, s88, 393216
L_skip_126:
L_end_125:
    s_cmp_ge_i32 s60, 0
    s_cbranch_scc0 L_skip_127
    s_cmp_lt_u32 s58, 5
    s_cbranch_scc0 L_skip_128
    s_lshl_b32 s62, s58, 7
    v_and_b32 v8, 1, v2
    v_lshlrev_b32 v8, 2, v8
    v_lshl_add_u32 v8, v3, 3, v8
    v_add_u32 v8, s62, v8
    v_lshlrev_b32 v40, 2, v8
    v_add_u32 v41, 5120, v40
    v_lshlrev_b32 v10, 1, v8
    v_lshrrev_b32 v11, 1, v2
    v_mul_u32_u24 v11, 1344, v11
    v_add_u32 v11, v11, v10
    v_add_u32 v59, 40960, v11
    v_add_u32 v60, 150144, v40
    v_and_b32 v11, 7, v1
    s_lshl_b32 s62, s60, 5
    v_lshl_add_u32 v11, v11, 2, s62
    v_min_u32 v11, 636, v11
    v_lshlrev_b32 v11, 2, v11
    v_add_u32 v12, 7680, v11
    v_add_u32 v61, 150144, v11
    v_mov_b32 v13, 0x7fff0000
    v_cmp_gt_u32 vcc, 8, v0
    s_nop 1
    v_cndmask_b32 v42, v13, v12, vcc
    s_mov_b32 s88, 114688
    buffer_load_dwordx2 v[44:45], v10, s[8:11], 0 offen
    buffer_load_dwordx4 v[236:239], v40, s[4:7], s88 offen sc1
    buffer_load_dwordx4 v[240:243], v40, s[4:7], s88 offen offset:2560 sc1
    buffer_load_dwordx4 v[244:247], v41, s[4:7], s88 offen sc1
    buffer_load_dwordx4 v[252:255], v42, s[4:7], s88 offen sc1
L_skip_128:
L_skip_127:
    s_cmp_lt_u32 s58, 4
    s_cbranch_scc0 L_skip_129
    v_mul_u32_u24 v7, 384, v50
    v_and_b32 v8, 1, v5
    v_lshl_add_u32 v7, v8, 3, v7
    v_add_u32 v7, 86016, v7
    v_lshrrev_b32 v8, 1, v5
    v_and_b32 v9, 2, v4
    v_or_b32 v8, v8, v9
    s_mul_i32 s62, s58, 6
    s_add_u32 s63, s62, 0
    v_xor_b32 v13, s63, v8
    v_lshl_add_u32 v13, v13, 4, v7
    ds_read_b64_tr_b16 v[124:125], v13 offset:0
    ds_read_b64_tr_b16 v[128:129], v13 offset:12288
    ds_read_b64_tr_b16 v[132:133], v13 offset:24576
    s_add_u32 s63, s62, 0
    s_xor_b32 s63, s63, 4
    v_xor_b32 v13, s63, v8
    v_lshl_add_u32 v13, v13, 4, v7
    ds_read_b64_tr_b16 v[126:127], v13 offset:1536
    ds_read_b64_tr_b16 v[130:131], v13 offset:13824
    ds_read_b64_tr_b16 v[134:135], v13 offset:26112
    s_add_u32 s63, s62, 2
    v_xor_b32 v13, s63, v8
    v_lshl_add_u32 v13, v13, 4, v7
    ds_read_b64_tr_b16 v[136:137], v13 offset:0
    ds_read_b64_tr_b16 v[140:141], v13 offset:12288
    ds_read_b64_tr_b16 v[144:145], v13 offset:24576
    s_add_u32 s63, s62, 2
    s_xor_b32 s63, s63, 4
    v_xor_b32 v13, s63, v8
    v_lshl_add_u32 v13, v13, 4, v7
    ds_read_b64_tr_b16 v[138:139], v13 offset:1536
    ds_read_b64_tr_b16 v[142:143], v13 offset:13824
    ds_read_b64_tr_b16 v[146:147], v13 offset:26112
    s_add_u32 s63, s62, 4
    v_xor_b32 v13, s63, v8
    v_lshl_add_u32 v13, v13, 4, v7
    ds_read_b64_tr_b16 v[148:149], v13 offset:0
    ds_read_b64_tr_b16 v[152:153], v13 offset:12288
    ds_read_b64_tr_b16 v[156:157], v13 offset:24576
    s_add_u32 s63, s62, 4
    s_xor_b32 s63, s63, 4
    v_xor_b32 v13, s63, v8
    v_lshl_add_u32 v13, v13, 4, v7
    ds_read_b64_tr_b16 v[150:151], v13 offset:1536
    ds_read_b64_tr_b16 v[154:155], v13 offset:13824
    ds_read_b64_tr_b16 v[158:159], v13 offset:26112
L_skip_129:
    s_mul_i32 s62, s66, 3072
    s_mul_i32 s67, s58, 384
    s_add_u32 s62, s62, s67
    s_add_u32 s62, s62, 1179648
    s_lshl_b32 s63, s55, 10
    s_add_u32 s63, s63, 1114112
    v_and_b32 v6, 7, v1
    v_lshlrev_b32 v6, 7, v6
    v_mov_b32 v8, 0x7fff0000
    v_cmp_gt_u32 vcc, 24, v1
    s_nop 1
    v_cndmask_b32 v8, v8, v30, vcc
    s_mul_i32 s64, s58, 800
    s_add_u32 s64, s64, 155648
    v_lshl_add_u32 v7, v1, 3, s64
    s_mov_b32 s68, 400000
L_poll_130:
    buffer_load_dwordx2 v[18:19], v6, s[4:7], s63 offen sc1
    buffer_load_dwordx4 v[14:17], v8, s[4:7], s62 offen sc1
    s_waitcnt vmcnt(0)
    v_max3_u32 v20, v14, v15, v16
    v_max3_u32 v20, v20, v17, v18
    v_max_u32 v20, v20, v19
    v_cmp_eq_u32 vcc, -1, v20
    s_cbranch_vccz L_pdone_131
    s_sub_u32 s68, s68, 1
    s_cbranch_scc0 L_poll_130
L_pdone_131:
    v_mov_b32 v20, v18
    s_nop 1
    v_max_f32_dpp v20, v20, v20 quad_perm:[1,0,3,2] row_mask:0xf bank_mask:0xf
    s_nop 1
    v_max_f32_dpp v20, v20, v20 quad_perm:[2,3,0,1] row_mask:0xf bank_mask:0xf
    s_nop 1
    v_max_f32_dpp v20, v20, v20 row_half_mirror row_mask:0xf bank_mask:0xf
    v_sub_f32 v18, v18, v20
    v_mul_f32 v18, s75, v18
    v_exp_f32 v18, v18
    s_nop 0
    v_mul_f32 v19, v18, v19
    s_nop 1
    v_add_f32_dpp v19, v19, v19 quad_perm:[1,0,3,2] row_mask:0xf bank_mask:0xf
    s_nop 1
    v_add_f32_dpp v19, v19, v19 quad_perm:[2,3,0,1] row_mask:0xf bank_mask:0xf
    s_nop 1
    v_add_f32_dpp v19, v19, v19 row_half_mirror row_mask:0xf bank_mask:0xf
    v_rcp_f32 v19, v19
    s_nop 0
    v_mul_f32 v18, v18, v19
    s_nop 0
    v_readlane_b32 s64, v18, s58
    s_mov_b32 exec_lo, 0xffffff
    s_mov_b32 exec_hi, 0
    v_mul_f32 v14, s64, v14
    v_mul_f32 v15, s64, v15
    v_mul_f32 v16, s64, v16
    v_mul_f32 v17, s64, v17
    v_cvt_pk_bf16_f32 v18, v14, v15
    v_lshlrev_b32 v22, 16, v18
    v_and_b32 v23, s78, v18
    v_sub_f32 v22, v14, v22
    v_sub_f32 v23, v15, v23
    v_cvt_pk_bf16_f32 v20, v22, v23
    v_cvt_pk_bf16_f32 v19, v16, v17
    v_lshlrev_b32 v24, 16, v19
    v_and_b32 v25, s78, v19
    v_sub_f32 v24, v16, v24
    v_sub_f32 v25, v17, v25
    v_cvt_pk_bf16_f32 v21, v24, v25
    ds_write_b64 v7, v[18:19]
    ds_write_b64 v7, v[20:21] offset:400
    s_mov_b64 exec, -1
    s_mul_i32 s62, s66, 768
    s_mul_i32 s67, s58, 192
    s_add_u32 s62, s62, s67
    s_add_u32 s62, s62, 655360
    s_waitcnt lgkmcnt(0)
    s_barrier
    s_cmp_lt_u32 s58, 4
    s_cbranch_scc0 L_skip_133
    ds_read_b128 v[64:67], v51 offset:0
    ds_read_b128 v[68:71], v51 offset:64
    ds_read_b128 v[72:75], v51 offset:128
    s_waitcnt lgkmcnt(2)
    v_mfma_f32_16x16x32_bf16 v[96:99], v[64:67], v[124:127], 0
    v_mfma_f32_16x16x32_bf16 v[100:103], v[64:67], v[136:139], 0
    v_mfma_f32_16x16x32_bf16 v[104:107], v[64:67], v[148:151], 0
    s_waitcnt lgkmcnt(1)
    v_mfma_f32_16x16x32_bf16 v[96:99], v[68:71], v[128:131], v[96:99]
    v_mfma_f32_16x16x32_bf16 v[100:103], v[68:71], v[140:143], v[100:103]
    v_mfma_f32_16x16x32_bf16 v[104:107], v[68:71], v[152:155], v[104:107]
    s_waitcnt lgkmcnt(0)
    v_mfma_f32_16x16x32_bf16 v[96:99], v[72:75], v[132:135], v[96:99]
    v_mfma_f32_16x16x32_bf16 v[100:103], v[72:75], v[144:147], v[100:103]
    v_mfma_f32_16x16x32_bf16 v[104:107], v[72:75], v[156:159], v[104:107]
    s_nop 5
    v_add_f32 v96, v96, v97
    v_add_f32 v98, v98, v99
    v_add_f32 v100, v100, v101
    v_add_f32 v102, v102, v103
    v_add_f32 v104, v104, v105
    v_add_f32 v106, v106, v107
    v_add_f32 v96, v96, v98
    v_add_f32 v100, v100, v102
    v_add_f32 v104, v104, v106
    v_mov_b32 v105, v104
    v_permlane32_swap_b32 v96, v100
    s_nop 0
    v_permlane32_swap_b32 v104, v105
    v_add_f32 v96, v96, v100
    v_add_f32 v104, v104, v105
    s_nop 1
    v_permlane16_swap_b32 v96, v104
    v_add_f32 v96, v96, v104
    s_cmp_eq_u32 s61, 2
    s_cbranch_scc0 L_skip_134
    buffer_store_dword v96, v52, s[4:7], s62 offen
    s_branch L_end_135
L_skip_134:
    buffer_store_dword v96, v52, s[4:7], s62 offen sc1
L_end_135:
L_skip_133:
    s_cmp_lt_u32 s56, 5
    s_cbranch_scc0 L_skip_136
    v_lshlrev_b32 v12, 8, v50
    v_and_b32 v13, 1, v5
    v_lshl_add_u32 v12, v13, 3, v12
    v_lshrrev_b32 v13, 1, v5
    v_lshl_or_b32 v13, v4, 1, v13
    s_lshl_b32 s62, s58, 2
    v_xor_b32 v13, s62, v13
    v_lshrrev_b32 v10, 1, v2
    v_lshlrev_b32 v53, 5, v10
    v_lshl_add_u32 v53, v3, 1, v53
    s_or_b64 vcc, s[72:73], s[84:85]
    v_mov_b32 v10, 0x7fff0000
    v_cndmask_b32 v53, v53, v10, vcc
    s_mul_i32 s62, s55, 6144
    s_mul_i32 s67, s58, 768
    s_add_u32 s62, s62, s67
    s_add_u32 s62, s62, 655360
    s_mul_i32 s63, s58, 800
    s_add_u32 s63, s63, 74752
    v_lshl_add_u32 v7, v1, 3, s63
    v_subrev_u32 v11, 80896, v51
    s_mov_b32 exec_lo, -1
    s_mov_b32 exec_hi, 0xffff
    s_cmp_eq_u32 s61, 2
    s_cbranch_scc0 L_skip_137
    buffer_load_dwordx4 v[14:17], v30, s[4:7], s62 offen nt
    s_branch L_end_138
L_skip_137:
    buffer_load_dwordx4 v[14:17], v30, s[4:7], s62 offen sc1
L_end_138:
    s_mov_b64 exec, -1
    s_cmp_lt_u32 s58, 4
    s_cbranch_scc0 L_skip_139
    v_xor_b32 v9, 0, v13
    v_lshl_add_u32 v9, v9, 4, v12
    ds_read_b64_tr_b16 v[160:161], v9 offset:0
    ds_read_b64_tr_b16 v[164:165], v9 offset:8192
    ds_read_b64_tr_b16 v[168:169], v9 offset:16384
    ds_read_b64_tr_b16 v[172:173], v9 offset:24576
    ds_read_b64_tr_b16 v[176:177], v9 offset:32768
    ds_read_b64_tr_b16 v[180:181], v9 offset:40960
    v_xor_b32 v9, 8, v13
    v_lshl_add_u32 v9, v9, 4, v12
    ds_read_b64_tr_b16 v[162:163], v9 offset:1024
    ds_read_b64_tr_b16 v[166:167], v9 offset:9216
    ds_read_b64_tr_b16 v[170:171], v9 offset:17408
    ds_read_b64_tr_b16 v[174:175], v9 offset:25600
    ds_read_b64_tr_b16 v[178:179], v9 offset:33792
    ds_read_b64_tr_b16 v[182:183], v9 offset:41984
    v_xor_b32 v9, 2, v13
    v_lshl_add_u32 v9, v9, 4, v12
    ds_read_b64_tr_b16 v[184:185], v9 offset:0
    ds_read_b64_tr_b16 v[188:189], v9 offset:8192
    ds_read_b64_tr_b16 v[192:193], v9 offset:16384
    ds_read_b64_tr_b16 v[196:197], v9 offset:24576
    ds_read_b64_tr_b16 v[200:201], v9 offset:32768
    ds_read_b64_tr_b16 v[204:205], v9 offset:40960
    v_xor_b32 v9, 10, v13
    v_lshl_add_u32 v9, v9, 4, v12
    ds_read_b64_tr_b16 v[186:187], v9 offset:1024
    ds_read_b64_tr_b16 v[190:191], v9 offset:9216
    ds_read_b64_tr_b16 v[194:195], v9 offset:17408
    ds_read_b64_tr_b16 v[198:199], v9 offset:25600
    ds_read_b64_tr_b16 v[202:203], v9 offset:33792
    ds_read_b64_tr_b16 v[206:207], v9 offset:41984
L_skip_139:
    s_mov_b32 exec_lo, -1
    s_mov_b32 exec_hi, 0xffff
    s_mov_b32 s68, 400000
    s_waitcnt vmcnt(0)
    s_branch L_pchk_142
L_poll_140:
    s_cmp_eq_u32 s61, 2
    s_cbranch_scc0 L_skip_143
    buffer_load_dwordx4 v[14:17], v30, s[4:7], s62 offen nt
    s_branch L_end_144
L_skip_143:
    buffer_load_dwordx4 v[14:17], v30, s[4:7], s62 offen sc1
L_end_144:
    s_waitcnt vmcnt(0)
L_pchk_142:
    v_max3_u32 v18, v14, v15, v16
    v_max_u32 v18, v18, v17
    v_cmp_eq_u32 vcc, -1, v18
    s_cbranch_vccz L_pdone_141
    s_sub_u32 s68, s68, 1
    s_cbranch_scc0 L_poll_140
L_pdone_141:
    v_cvt_pk_bf16_f32 v18, v14, v15
    v_lshlrev_b32 v22, 16, v18
    v_and_b32 v23, s78, v18
    v_sub_f32 v22, v14, v22
    v_sub_f32 v23, v15, v23
    v_cvt_pk_bf16_f32 v20, v22, v23
    v_cvt_pk_bf16_f32 v19, v16, v17
    v_lshlrev_b32 v24, 16, v19
    v_and_b32 v25, s78, v19
    v_sub_f32 v24, v16, v24
    v_sub_f32 v25, v17, v25
    v_cvt_pk_bf16_f32 v21, v24, v25
    ds_write_b64 v7, v[18:19]
    ds_write_b64 v7, v[20:21] offset:400
    s_mov_b64 exec, -1
    s_mul_i32 s62, s55, 1280
    s_lshl_b32 s67, s56, 8
    s_add_u32 s62, s62, s67
    s_lshl_b32 s67, s58, 6
    s_add_u32 s62, s62, s67
    s_add_u32 s62, s62, 851968
    s_waitcnt lgkmcnt(0)
    s_barrier
    s_cmp_lt_u32 s58, 4
    s_cbranch_scc0 L_skip_145
    ds_read_b128 v[64:67], v11 offset:0
    ds_read_b128 v[68:71], v11 offset:64
    ds_read_b128 v[72:75], v11 offset:128
    ds_read_b128 v[76:79], v11 offset:192
    ds_read_b128 v[80:83], v11 offset:256
    ds_read_b128 v[84:87], v11 offset:320
    s_waitcnt lgkmcnt(5)
    v_mfma_f32_16x16x32_bf16 v[96:99], v[64:67], v[160:163], 0
    v_mfma_f32_16x16x32_bf16 v[100:103], v[64:67], v[184:187], 0
    s_waitcnt lgkmcnt(4)
    v_mfma_f32_16x16x32_bf16 v[96:99], v[68:71], v[164:167], v[96:99]
    v_mfma_f32_16x16x32_bf16 v[100:103], v[68:71], v[188:191], v[100:103]
    s_waitcnt lgkmcnt(3)
    v_mfma_f32_16x16x32_bf16 v[96:99], v[72:75], v[168:171], v[96:99]
    v_mfma_f32_16x16x32_bf16 v[100:103], v[72:75], v[192:195], v[100:103]
    s_waitcnt lgkmcnt(2)
    v_mfma_f32_16x16x32_bf16 v[96:99], v[76:79], v[172:175], v[96:99]
    v_mfma_f32_16x16x32_bf16 v[100:103], v[76:79], v[196:199], v[100:103]
    s_waitcnt lgkmcnt(1)
    v_mfma_f32_16x16x32_bf16 v[96:99], v[80:83], v[176:179], v[96:99]
    v_mfma_f32_16x16x32_bf16 v[100:103], v[80:83], v[200:203], v[100:103]
    s_waitcnt lgkmcnt(0)
    v_mfma_f32_16x16x32_bf16 v[96:99], v[84:87], v[180:183], v[96:99]
    v_mfma_f32_16x16x32_bf16 v[100:103], v[84:87], v[204:207], v[100:103]
    s_nop 6
    v_add_f32 v96, v96, v97
    v_add_f32 v98, v98, v99
    v_add_f32 v100, v100, v101
    v_add_f32 v102, v102, v103
    v_add_f32 v96, v96, v98
    v_add_f32 v100, v100, v102
    s_nop 1
    v_permlane32_swap_b32 v96, v100
    v_add_f32 v96, v96, v100
    v_mov_b32 v97, v96
    s_nop 1
    v_permlane16_swap_b32 v96, v97
    v_add_f32 v96, v96, v97
    s_nop 1
    v_mov_b32_dpp v97, v96 quad_perm:[1,1,3,3] row_mask:0xf bank_mask:0xf
    v_cvt_pk_bf16_f32 v98, v96, v97
    buffer_store_dword v98, v53, s[4:7], s62 offen sc1
L_skip_145:
    s_branch L_end_146
L_skip_136:
    s_cmp_ge_i32 s60, 0
    s_cbranch_scc0 L_skip_147
    s_mul_i32 s88, s60, 40960
    s_lshl_b32 s67, s58, 10
    s_add_u32 s88, s88, s67
    s_lshl_b32 s86, s58, 10
    s_add_u32 s86, s86, 86016
    s_mov_b32 m0, s86
    s_nop 0
    buffer_load_dwordx4 v30, s[36:39], s88 offen nt lds
    s_add_u32 m0, m0, 8192
    s_add_u32 s88, s88, 8192
    buffer_load_dwordx4 v30, s[36:39], s88 offen nt lds
    s_add_u32 m0, m0, 8192
    s_add_u32 s88, s88, 8192
    buffer_load_dwordx4 v30, s[36:39], s88 offen nt lds
    s_add_u32 m0, m0, 8192
    s_add_u32 s88, s88, 8192
    buffer_load_dwordx4 v30, s[36:39], s88 offen nt lds
    s_add_u32 m0, m0, 8192
    s_add_u32 s88, s88, 8192
    buffer_load_dwordx4 v30, s[36:39], s88 offen nt lds
    s_cmp_lt_u32 s58, 5
    s_cbranch_scc0 L_skip_148
    s_mov_b32 s88, 114688
    s_mov_b32 s68, 400000
    s_waitcnt vmcnt(63)
    s_branch L_pchk_151
L_poll_149:
    buffer_load_dwordx4 v[236:239], v40, s[4:7], s88 offen sc1
    buffer_load_dwordx4 v[240:243], v40, s[4:7], s88 offen offset:2560 sc1
    buffer_load_dwordx4 v[244:247], v41, s[4:7], s88 offen sc1
    buffer_load_dwordx4 v[252:255], v42, s[4:7], s88 offen sc1
    s_waitcnt vmcnt(0)
L_pchk_151:
    v_max3_u32 v18, v236, v237, v238
    v_max3_u32 v18, v18, v239, v240
    v_max3_u32 v18, v18, v241, v242
    v_max3_u32 v18, v18, v243, v244
    v_max3_u32 v18, v18, v245, v246
    v_max3_u32 v18, v18, v247, v252
    v_max3_u32 v18, v18, v253, v254
    v_max_u32 v18, v18, v255
    v_cmp_eq_u32 vcc, -1, v18
    s_cbranch_vccz L_pdone_150
    s_sub_u32 s68, s68, 1
    s_cbranch_scc0 L_poll_149
L_pdone_150:
    v_add_f32 v244, 1.0, v244
    v_add_f32 v245, 1.0, v245
    v_add_f32 v246, 1.0, v246
    v_add_f32 v247, 1.0, v247
    v_lshlrev_b32 v248, 16, v44
    v_and_b32 v249, s78, v44
    v_lshlrev_b32 v250, 16, v45
    v_and_b32 v251, s78, v45
    v_cvt_pk_bf16_f32 v14, v244, v245
    v_lshlrev_b32 v18, 16, v14
    v_and_b32 v19, s78, v14
    v_sub_f32 v18, v244, v18
    v_sub_f32 v19, v245, v19
    v_cvt_pk_bf16_f32 v16, v18, v19
    v_cvt_pk_bf16_f32 v15, v246, v247
    v_lshlrev_b32 v20, 16, v15
    v_and_b32 v21, s78, v15
    v_sub_f32 v20, v246, v20
    v_sub_f32 v21, v247, v21
    v_cvt_pk_bf16_f32 v17, v20, v21
    v_cndmask_b32 v14, v14, v16, s[82:83]
    v_cndmask_b32 v15, v15, v17, s[82:83]
    ds_write_b64 v59, v[14:15] offset:2688
    v_cvt_pk_bf16_f32 v14, v240, v241
    v_lshlrev_b32 v18, 16, v14
    v_and_b32 v19, s78, v14
    v_sub_f32 v18, v240, v18
    v_sub_f32 v19, v241, v19
    v_cvt_pk_bf16_f32 v16, v18, v19
    v_cvt_pk_bf16_f32 v15, v242, v243
    v_lshlrev_b32 v20, 16, v15
    v_and_b32 v21, s78, v15
    v_sub_f32 v20, v242, v20
    v_sub_f32 v21, v243, v21
    v_cvt_pk_bf16_f32 v17, v20, v21
    v_cndmask_b32 v14, v14, v16, s[82:83]
    v_cndmask_b32 v15, v15, v17, s[82:83]
    ds_write_b64 v59, v[14:15] offset:5376
L_skip_148:
    s_cmp_lt_u32 s58, 4
    s_cbranch_scc0 L_skip_152
    v_lshlrev_b32 v7, 6, v50
    v_lshl_add_u32 v7, v5, 3, v7
    s_lshr_b32 s62, s58, 1
    s_and_b32 s63, s58, 1
    s_mul_i32 s62, s62, 20480
    s_lshl_b32 s67, s63, 5
    s_add_u32 s62, s62, s67
    v_add_u32 v7, s62, v7
    ds_read_b64_tr_b16 v[160:161], v7 offset:0
    ds_read_b64_tr_b16 v[162:163], v7 offset:256
    ds_read_b64_tr_b16 v[164:165], v7 offset:2048
    ds_read_b64_tr_b16 v[166:167], v7 offset:2304
    ds_read_b64_tr_b16 v[168:169], v7 offset:4096
    ds_read_b64_tr_b16 v[170:171], v7 offset:4352
    ds_read_b64_tr_b16 v[172:173], v7 offset:6144
    ds_read_b64_tr_b16 v[174:175], v7 offset:6400
    ds_read_b64_tr_b16 v[176:177], v7 offset:8192
    ds_read_b64_tr_b16 v[178:179], v7 offset:8448
    ds_read_b64_tr_b16 v[180:181], v7 offset:10240
    ds_read_b64_tr_b16 v[182:183], v7 offset:10496
    ds_read_b64_tr_b16 v[184:185], v7 offset:12288
    ds_read_b64_tr_b16 v[186:187], v7 offset:12544
    ds_read_b64_tr_b16 v[188:189], v7 offset:14336
    ds_read_b64_tr_b16 v[190:191], v7 offset:14592
    ds_read_b64_tr_b16 v[192:193], v7 offset:16384
    ds_read_b64_tr_b16 v[194:195], v7 offset:16640
    ds_read_b64_tr_b16 v[196:197], v7 offset:18432
    ds_read_b64_tr_b16 v[198:199], v7 offset:18688
L_skip_152:
    v_mul_u32_u24 v7, 1280, v50
    v_lshl_add_u32 v7, v5, 3, v7
    s_mul_i32 s62, s58, 160
    s_add_u32 s62, s62, 86016
    v_add_u32 v7, s62, v7
    s_mul_i32 s62, s58, 5
    v_add_u32 v8, s62, v2
    v_lshrrev_b32 v9, 1, v8
    v_mul_u32_u24 v9, 6144, v9
    v_and_b32 v8, 1, v8
    v_lshl_add_u32 v9, v8, 6, v9
    v_lshl_add_u32 v54, v3, 2, v9
    s_add_u32 s62, s62, 4
    s_lshr_b32 s63, s62, 1
    s_and_b32 s62, s62, 1
    s_lshl_b32 s62, s62, 6
    s_mul_i32 s67, s63, 6144
    s_add_u32 s62, s62, s67
    v_lshl_add_u32 v55, v3, 2, s62
    v_and_b32 v8, 1, v3
    v_mul_u32_u24 v8, 1344, v8
    v_lshl_add_u32 v8, v2, 4, v8
    s_lshr_b32 s62, s58, 1
    s_mul_i32 s62, s62, 640
    s_add_u32 s62, s62, 40960
    v_add_u32 v56, s62, v8
    s_lshl_b32 s62, s58, 6
    s_add_u32 s62, s62, 152768
    v_lshl_add_u32 v57, v3, 2, s62
    v_lshlrev_b32 v8, 5, v2
    v_add_u32 v58, 152768, v8
    v_and_b32 v11, 1, v3
    v_mov_b32 v12, 0x3f80
    v_lshlrev_b32 v11, 4, v11
    v_lshlrev_b32 v12, v11, v12
    v_bfe_u32 v11, v3, 1, 2
    v_cmp_eq_u32 vcc, 0, v11
    s_nop 1
    v_cndmask_b32 v220, 0, v12, vcc
    v_cmp_eq_u32 vcc, 1, v11
    s_nop 1
    v_cndmask_b32 v221, 0, v12, vcc
    v_cmp_eq_u32 vcc, 2, v11
    s_nop 1
    v_cndmask_b32 v222, 0, v12, vcc
    v_cmp_eq_u32 vcc, 3, v11
    s_nop 1
    v_cndmask_b32 v223, 0, v12, vcc
    v_mov_b32 v26, v7
    s_waitcnt lgkmcnt(0)
    s_barrier
    s_cmp_lt_u32 s58, 4
    s_cbranch_scc0 L_skip_153
    v_and_b32 v8, 2, v3
    v_mul_u32_u24 v8, 1344, v8
    v_add_u32 v8, v8, v56
    ds_read_b128 v[64:67], v8 offset:2688
    ds_read_b128 v[68:71], v8 offset:2752
    ds_read_b128 v[72:75], v8 offset:2816
    ds_read_b128 v[76:79], v8 offset:2880
    ds_read_b128 v[80:83], v8 offset:2944
    ds_read_b128 v[84:87], v8 offset:3008
    ds_read_b128 v[88:91], v8 offset:3072
    ds_read_b128 v[92:95], v8 offset:3136
    ds_read_b128 v[96:99], v8 offset:3200
    ds_read_b128 v[100:103], v8 offset:3264
    s_waitcnt lgkmcnt(9)
    v_mfma_f32_16x16x32_bf16 v[104:107], v[64:67], v[160:163], 0
    s_waitcnt lgkmcnt(8)
    v_mfma_f32_16x16x32_bf16 v[104:107], v[68:71], v[164:167], v[104:107]
    s_waitcnt lgkmcnt(7)
    v_mfma_f32_16x16x32_bf16 v[104:107], v[72:75], v[168:171], v[104:107]
    s_waitcnt lgkmcnt(6)
    v_mfma_f32_16x16x32_bf16 v[104:107], v[76:79], v[172:175], v[104:107]
    s_waitcnt lgkmcnt(5)
    v_mfma_f32_16x16x32_bf16 v[104:107], v[80:83], v[176:179], v[104:107]
    s_waitcnt lgkmcnt(4)
    v_mfma_f32_16x16x32_bf16 v[104:107], v[84:87], v[180:183], v[104:107]
    s_waitcnt lgkmcnt(3)
    v_mfma_f32_16x16x32_bf16 v[104:107], v[88:91], v[184:187], v[104:107]
    s_waitcnt lgkmcnt(2)
    v_mfma_f32_16x16x32_bf16 v[104:107], v[92:95], v[188:191], v[104:107]
    s_waitcnt lgkmcnt(1)
    v_mfma_f32_16x16x32_bf16 v[104:107], v[96:99], v[192:195], v[104:107]
    s_waitcnt lgkmcnt(0)
    v_mfma_f32_16x16x32_bf16 v[104:107], v[100:103], v[196:199], v[104:107]
    s_nop 7
    v_add_f32 v224, v104, v105
    v_add_f32 v225, v106, v107
L_skip_153:
    s_waitcnt vmcnt(0)
    s_waitcnt lgkmcnt(0)
    s_barrier
    ds_read_b64_tr_b16 v[200:201], v26 offset:0
    ds_read_b64_tr_b16 v[202:203], v26 offset:5120
    ds_read_b64_tr_b16 v[204:205], v26 offset:32
    ds_read_b64_tr_b16 v[206:207], v26 offset:5152
    ds_read_b64_tr_b16 v[208:209], v26 offset:64
    ds_read_b64_tr_b16 v[210:211], v26 offset:5184
    ds_read_b64_tr_b16 v[212:213], v26 offset:96
    ds_read_b64_tr_b16 v[214:215], v26 offset:5216
    ds_read_b64_tr_b16 v[216:217], v26 offset:128
    ds_read_b64_tr_b16 v[218:219], v26 offset:5248
    s_cmp_lt_u32 s58, 5
    s_cbranch_scc0 L_skip_154
    v_mul_u32_u24 v6, 2560, v2
    v_lshl_add_u32 v6, v3, 4, v6
    s_lshl_b32 s62, s58, 8
    s_add_u32 s62, s62, 851968
    s_add_u32 s63, s62, 10240
    s_add_u32 s64, s62, 20480
    s_add_u32 s65, s62, 30720
    s_mov_b32 s68, 400000
L_poll_155:
    buffer_load_dwordx4 v[64:67], v6, s[4:7], s62 offen sc1
    buffer_load_dwordx4 v[68:71], v6, s[4:7], s62 offen offset:1280 sc1
    buffer_load_dwordx4 v[72:75], v6, s[4:7], s63 offen sc1
    buffer_load_dwordx4 v[76:79], v6, s[4:7], s63 offen offset:1280 sc1
    buffer_load_dwordx4 v[80:83], v6, s[4:7], s64 offen sc1
    buffer_load_dwordx4 v[84:87], v6, s[4:7], s64 offen offset:1280 sc1
    buffer_load_dwordx4 v[88:91], v6, s[4:7], s65 offen sc1
    buffer_load_dwordx4 v[92:95], v6, s[4:7], s65 offen offset:1280 sc1
    s_waitcnt vmcnt(0)
    v_max3_u32 v14, v64, v65, v66
    v_max3_u32 v14, v14, v67, v68
    v_max3_u32 v14, v14, v69, v70
    v_max3_u32 v14, v14, v71, v72
    v_max3_u32 v14, v14, v73, v74
    v_max3_u32 v14, v14, v75, v76
    v_max3_u32 v14, v14, v77, v78
    v_max3_u32 v14, v14, v79, v80
    v_max3_u32 v14, v14, v81, v82
    v_max3_u32 v14, v14, v83, v84
    v_max3_u32 v14, v14, v85, v86
    v_max3_u32 v14, v14, v87, v88
    v_max3_u32 v14, v14, v89, v90
    v_max3_u32 v14, v14, v91, v92
    v_max3_u32 v14, v14, v93, v94
    v_max_u32 v14, v14, v95
    v_cmp_eq_u32 vcc, -1, v14
    s_cbranch_vccz L_pdone_156
    s_sub_u32 s68, s68, 1
    s_cbranch_scc0 L_poll_155
L_pdone_156:
    v_mfma_f32_16x16x32_bf16 v[96:99], v[220:223], v[64:67], 0
    v_mfma_f32_16x16x32_bf16 v[100:103], v[220:223], v[68:71], 0
    v_mfma_f32_16x16x32_bf16 v[96:99], v[220:223], v[72:75], v[96:99]
    v_mfma_f32_16x16x32_bf16 v[100:103], v[220:223], v[76:79], v[100:103]
    v_mfma_f32_16x16x32_bf16 v[96:99], v[220:223], v[80:83], v[96:99]
    v_mfma_f32_16x16x32_bf16 v[100:103], v[220:223], v[84:87], v[100:103]
    v_mfma_f32_16x16x32_bf16 v[96:99], v[220:223], v[88:91], v[96:99]
    v_mfma_f32_16x16x32_bf16 v[100:103], v[220:223], v[92:95], v[100:103]
    s_lshl_b32 s63, s58, 3
    s_add_u32 s63, s63, 152704
    s_nop 5
    v_add_f32 v96, v96, v100
    v_add_f32 v97, v97, v101
    v_add_f32 v98, v98, v102
    v_add_f32 v99, v99, v103
    v_fmac_f32 v248, v236, v96
    v_fmac_f32 v249, v237, v97
    v_fmac_f32 v250, v238, v98
    v_fmac_f32 v251, v239, v99
    v_readfirstlane_b32 s62, v248
    v_mul_f32 v100, v248, v244
    v_mul_f32 v101, v249, v245
    v_mul_f32 v102, v250, v246
    v_mul_f32 v103, v251, v247
    v_cvt_pk_bf16_f32 v14, v100, v101
    v_lshlrev_b32 v18, 16, v14
    v_and_b32 v19, s78, v14
    v_sub_f32 v18, v100, v18
    v_sub_f32 v19, v101, v19
    v_cvt_pk_bf16_f32 v16, v18, v19
    v_cvt_pk_bf16_f32 v15, v102, v103
    v_lshlrev_b32 v20, 16, v15
    v_and_b32 v21, s78, v15
    v_sub_f32 v20, v102, v20
    v_sub_f32 v21, v103, v21
    v_cvt_pk_bf16_f32 v17, v20, v21
    v_cndmask_b32 v14, v14, v16, s[82:83]
    v_cndmask_b32 v15, v15, v17, s[82:83]
    ds_write_b64 v59, v[14:15] offset:0
    v_mov_b32 v18, s63
    ds_write_b128 v60, v[248:251]
    v_subrev_f32 v96, s62, v248
    v_subrev_f32 v97, s62, v249
    v_subrev_f32 v98, s62, v250
    v_subrev_f32 v99, s62, v251
    v_add_f32 v14, v96, v97
    v_mul_f32 v15, v96, v96
    v_add_f32 v14, v14, v98
    v_fmac_f32 v15, v97, v97
    v_add_f32 v14, v14, v99
    v_fmac_f32 v15, v98, v98
    v_fmac_f32 v15, v99, v99
    v_add_f32_dpp v14, v14, v14 quad_perm:[1,0,3,2] row_mask:0xf bank_mask:0xf
    s_nop 0
    v_add_f32_dpp v15, v15, v15 quad_perm:[1,0,3,2] row_mask:0xf bank_mask:0xf
    v_add_f32_dpp v14, v14, v14 quad_perm:[2,3,0,1] row_mask:0xf bank_mask:0xf
    s_nop 0
    v_add_f32_dpp v15, v15, v15 quad_perm:[2,3,0,1] row_mask:0xf bank_mask:0xf
    v_add_f32_dpp v14, v14, v14 row_half_mirror row_mask:0xf bank_mask:0xf
    s_nop 0
    v_add_f32_dpp v15, v15, v15 row_half_mirror row_mask:0xf bank_mask:0xf
    v_add_f32_dpp v14, v14, v14 row_mirror row_mask:0xf bank_mask:0xf
    s_nop 0
    v_add_f32_dpp v15, v15, v15 row_mirror row_mask:0xf bank_mask:0xf
    s_nop 1
    v_permlane16_swap_b32 v14, v15
    v_add_f32 v14, v14, v15
    s_nop 0
    v_readlane_b32 s64, v14, 0
    v_readlane_b32 s65, v14, 16
    v_mov_b32 v16, 0x3c000000
    v_mul_f32 v16, s64, v16
    v_mov_b32 v15, s65
    v_add_f32 v14, s62, v16
    v_fma_f32 v15, -v16, s64, v15
    ds_write_b64 v18, v[14:15]
L_skip_154:
    v_mov_b32 v6, 152704
    s_waitcnt lgkmcnt(0)
    s_barrier
    s_cmp_lt_u32 s58, 4
    s_cbranch_scc0 L_skip_158
    ds_read_b128 v[14:17], v6
    ds_read_b128 v[18:21], v6 offset:16
    ds_read_b64 v[22:23], v6 offset:32
    ds_read_b128 v[64:67], v56 offset:0
    ds_read_b128 v[68:71], v56 offset:64
    ds_read_b128 v[72:75], v56 offset:128
    ds_read_b128 v[76:79], v56 offset:192
    ds_read_b128 v[80:83], v56 offset:256
    ds_read_b128 v[84:87], v56 offset:320
    ds_read_b128 v[88:91], v56 offset:384
    ds_read_b128 v[92:95], v56 offset:448
    ds_read_b128 v[96:99], v56 offset:512
    ds_read_b128 v[100:103], v56 offset:576
    s_waitcnt lgkmcnt(9)
    v_mfma_f32_16x16x32_bf16 v[104:107], v[64:67], v[160:163], 0
    v_add_f32 v7, v14, v16
    v_add_f32 v8, v18, v20
    v_add_f32 v9, v15, v17
    s_waitcnt lgkmcnt(8)
    v_mfma_f32_16x16x32_bf16 v[104:107], v[68:71], v[164:167], v[104:107]
    v_add_f32 v7, v7, v22
    v_add_f32 v9, v9, v19
    v_add_f32 v7, v7, v8
    s_waitcnt lgkmcnt(7)
    v_mfma_f32_16x16x32_bf16 v[104:107], v[72:75], v[168:171], v[104:107]
    v_add_f32 v9, v9, v21
    v_mul_f32 v7, 0x3e4ccccd, v7
    v_add_f32 v9, v9, v23
    s_waitcnt lgkmcnt(6)
    v_mfma_f32_16x16x32_bf16 v[104:107], v[76:79], v[172:175], v[104:107]
    v_sub_f32 v14, v14, v7
    v_sub_f32 v16, v16, v7
    v_sub_f32 v18, v18, v7
    s_waitcnt lgkmcnt(5)
    v_mfma_f32_16x16x32_bf16 v[104:107], v[80:83], v[176:179], v[104:107]
    v_sub_f32 v20, v20, v7
    v_sub_f32 v22, v22, v7
    v_mul_f32 v8, v14, v14
    s_waitcnt lgkmcnt(4)
    v_mfma_f32_16x16x32_bf16 v[104:107], v[84:87], v[180:183], v[104:107]
    v_fmac_f32 v8, v16, v16
    v_fmac_f32 v8, v18, v18
    v_fmac_f32 v8, v20, v20
    s_waitcnt lgkmcnt(3)
    v_mfma_f32_16x16x32_bf16 v[104:107], v[88:91], v[184:187], v[104:107]
    v_fmac_f32 v8, v22, v22
    v_mov_b32 v10, 0x3727c5ac
    v_fmac_f32 v10, 0x3acccccd, v9
    s_waitcnt lgkmcnt(2)
    v_mfma_f32_16x16x32_bf16 v[104:107], v[92:95], v[188:191], v[104:107]
    v_fmac_f32 v10, 0x3e4ccccd, v8
    v_rsq_f32 v10, v10
    v_mul_f32 v224, v224, v7
    s_waitcnt lgkmcnt(1)
    v_mfma_f32_16x16x32_bf16 v[104:107], v[96:99], v[192:195], v[104:107]
    s_waitcnt lgkmcnt(0)
    v_mfma_f32_16x16x32_bf16 v[104:107], v[100:103], v[196:199], v[104:107]
    s_nop 7
    v_add_f32 v104, v104, v105
    v_sub_f32 v104, v104, v224
    v_fma_f32 v104, v104, v10, v225
    ds_write_b32 v57, v104
L_skip_158:
    s_lshl_b32 s62, s60, 7
    s_add_u32 s62, s62, 917504
    s_waitcnt lgkmcnt(0)
    s_barrier
    ds_read_b128 v[64:67], v58
    ds_read_b128 v[72:75], v58 offset:128
    ds_read_b128 v[68:71], v58 offset:16
    ds_read_b128 v[76:79], v58 offset:144
    s_waitcnt lgkmcnt(2)
    v_pk_add_f32 v[64:65], v[64:65], v[72:73]
    v_pk_add_f32 v[66:67], v[66:67], v[74:75]
    v_max_f32 v64, 0, v64
    v_max_f32 v65, 0, v65
    v_max_f32 v66, 0, v66
    v_max_f32 v67, 0, v67
    v_cvt_pk_bf16_f32 v80, v64, v65
    v_cvt_pk_bf16_f32 v81, v66, v67
    s_waitcnt lgkmcnt(0)
    v_pk_add_f32 v[68:69], v[68:69], v[76:77]
    v_pk_add_f32 v[70:71], v[70:71], v[78:79]
    v_max_f32 v68, 0, v68
    v_max_f32 v69, 0, v69
    v_max_f32 v70, 0, v70
    v_max_f32 v71, 0, v71
    v_cvt_pk_bf16_f32 v82, v68, v69
    v_cvt_pk_bf16_f32 v83, v70, v71
    s_nop 1
    v_mfma_f32_16x16x32_bf16 v[84:87], v[80:83], v[200:203], 0
    v_mfma_f32_16x16x32_bf16 v[88:91], v[80:83], v[204:207], 0
    v_mfma_f32_16x16x32_bf16 v[92:95], v[80:83], v[208:211], 0
    v_mfma_f32_16x16x32_bf16 v[96:99], v[80:83], v[212:215], 0
    v_mfma_f32_16x16x32_bf16 v[100:103], v[80:83], v[216:219], 0
    s_nop 4
    v_cndmask_b32 v84, v84, v88, s[84:85]
    s_nop 0
    v_cndmask_b32 v92, v92, v96, s[84:85]
    v_cndmask_b32 v84, v84, v92, s[82:83]
    buffer_store_dword v84, v54, s[4:7], s62 offen sc1
    s_mov_b32 exec_lo, 0xffff
    s_mov_b32 exec_hi, 0
    buffer_store_dword v100, v55, s[4:7], s62 offen sc1
    s_mov_b64 exec, -1
    s_cmp_lt_u32 s60, 20
    s_cbranch_scc0 L_skip_159
    v_and_b32 v9, 7, v1
    v_lshlrev_b32 v9, 4, v9
    v_and_b32 v10, 1, v2
    v_lshl_add_u32 v9, v10, 3, v9
    v_lshrrev_b32 v10, 1, v2
    v_lshl_add_u32 v9, v10, 2, v9
    s_lshl_b32 s63, s58, 7
    s_add_u32 s63, s63, 153024
    v_add_u32 v9, s63, v9
    ds_read_b128 v[18:21], v61
    v_lshlrev_b32 v7, 3, v1
    v_add_u32 v11, 153024, v30
    s_lshl_b32 s64, s60, 6
    s_cmp_lt_u32 s58, 6
    s_cbranch_scc0 L_skip_160
    s_mul_i32 s62, s60, 6144
    s_lshl_b32 s67, s58, 10
    s_add_u32 s62, s62, s67
    s_add_u32 s62, s62, 917504
    s_lshl_b32 s63, s58, 7
    s_add_u32 s63, s63, 153024
    v_add_u32 v8, s63, v30
    s_mov_b32 s68, 400000
L_poll_161:
    buffer_load_dwordx4 v[64:67], v30, s[4:7], s62 offen sc1
    s_waitcnt vmcnt(0)
    v_max3_u32 v14, v64, v65, v66
    v_max_u32 v14, v14, v67
    v_cmp_eq_u32 vcc, -1, v14
    s_cbranch_vccz L_pdone_162
    s_sub_u32 s68, s68, 1
    s_cbranch_scc0 L_poll_161
L_pdone_162:
    v_add_f32_dpp v64, v64, v64 row_ror:8 row_mask:0xf bank_mask:0xf
    v_add_f32_dpp v65, v65, v65 row_ror:8 row_mask:0xf bank_mask:0xf
    v_add_f32_dpp v66, v66, v66 row_ror:8 row_mask:0xf bank_mask:0xf
    v_add_f32_dpp v67, v67, v67 row_ror:8 row_mask:0xf bank_mask:0xf
    v_permlane32_swap_b32 v64, v65
    s_nop 0
    v_permlane32_swap_b32 v66, v67
    v_add_f32 v64, v64, v65
    v_add_f32 v66, v66, v67
    s_nop 1
    v_permlane16_swap_b32 v64, v66
    v_add_f32 v64, v64, v66
    ds_write_b32 v9, v64
L_skip_160:
    s_waitcnt lgkmcnt(0)
    s_barrier
    s_cmp_eq_u32 s58, 0
    s_cbranch_scc0 L_skip_164
    s_mov_b32 exec_lo, 0xff
    s_mov_b32 exec_hi, 0
    ds_read_b128 v[64:67], v11 offset:0
    ds_read_b128 v[68:71], v11 offset:128
    ds_read_b128 v[72:75], v11 offset:256
    ds_read_b128 v[76:79], v11 offset:384
    ds_read_b128 v[80:83], v11 offset:512
    ds_read_b128 v[84:87], v11 offset:640
    s_waitcnt lgkmcnt(4)
    v_pk_add_f32 v[64:65], v[64:65], v[68:69]
    v_pk_add_f32 v[66:67], v[66:67], v[70:71]
    s_waitcnt lgkmcnt(2)
    v_pk_add_f32 v[72:73], v[72:73], v[76:77]
    v_pk_add_f32 v[74:75], v[74:75], v[78:79]
    s_waitcnt lgkmcnt(0)
    v_pk_add_f32 v[80:81], v[80:81], v[84:85]
    v_pk_add_f32 v[82:83], v[82:83], v[86:87]
    v_pk_add_f32 v[64:65], v[64:65], v[72:73]
    v_pk_add_f32 v[66:67], v[66:67], v[74:75]
    v_pk_add_f32 v[64:65], v[64:65], v[80:81]
    v_pk_add_f32 v[66:67], v[66:67], v[82:83]
    v_fmac_f32 v18, v252, v64
    v_fmac_f32 v19, v253, v65
    v_fmac_f32 v20, v254, v66
    v_fmac_f32 v21, v255, v67
    v_cvt_pk_bf16_f32 v14, v18, v19
    v_cvt_pk_bf16_f32 v15, v20, v21
    buffer_store_dwordx2 v[14:15], v7, s[48:51], s64 offen
    s_cmp_eq_u32 s60, 0
    s_cbranch_scc0 L_skip_165
    v_mov_b32 v16, s3
    s_mov_b64 exec, 1
    buffer_store_dword v16, v30, s[4:7], 0 offen sc1
L_skip_165:
    s_mov_b64 exec, -1
L_skip_164:
L_skip_159:
L_skip_147:
L_end_146:
L_fin:
L_exit:
    s_endpgm
.section .rodata,"a"
.p2align 6
.amdhsa_kernel adaLN_cond__compressed_kv_cla__dense_activation_relu__decode_kernel
  .amdhsa_next_free_vgpr 256
  .amdhsa_next_free_sgpr 100
  .amdhsa_accum_offset 256
  .amdhsa_group_segment_fixed_size 0
  .amdhsa_kernarg_size 112
  .amdhsa_user_sgpr_count 2
  .amdhsa_user_sgpr_kernarg_segment_ptr 1
  .amdhsa_system_sgpr_workgroup_id_x 1
.end_amdhsa_kernel
```
